```python
import torch

def _softmax(x, axis=-1):
    return torch.softmax(x, dim=axis)
def _gelu(x):
    return torch.nn.functional.gelu(x, approximate="tanh")
def _silu(x):
    return torch.nn.functional.silu(x)
def _sigmoid(x):
    return torch.sigmoid(x)
def _layernorm(x, axis=-1, eps=1e-5):
    m = x.mean(dim=axis, keepdim=True)
    v = x.var(dim=axis, keepdim=True, unbiased=False)
    return (x - m) / torch.sqrt(v + eps)
def _scatter_add(tgt, idx, src, axis=0):
    return tgt.clone().index_add_(axis, idx, src)
def _segment_sum(src, seg, n):
    out = torch.zeros((n,) + src.shape[1:], dtype=src.dtype)
    return out.index_add_(0, seg, src)
def _pad(x, pw):
    flat = tuple(v for pair in reversed(pw) for v in pair)
    return torch.nn.functional.pad(x, flat)

kernel_name = 'standalone__paged_block_table_kv_pagedattention__sampling'

def setup_inputs():

    _w = (lambda a: (lambda t: t.to(torch.bfloat16) if t.is_floating_point() else t)(torch.as_tensor(a)))
    B, Hq, Hkv, Sq, Skv, D = 8, 32, 8, 8, 4096, 128
    bs = 16
    nbps = max(1, Skv // bs)
    num_phys = B * nbps + 4
    bt = torch.randperm(num_phys)[: B * nbps].reshape(B, nbps).to(torch.int64)
    cl = (nbps * bs - (torch.arange(1, B + 1, dtype=torch.int64) * 2654435761) % max(1, nbps * bs // 2)).to(torch.int64)
    return {
        "q": _w((lambda *s: torch.randn(*s, dtype=torch.bfloat16) * 0.8)(B, Hq, Sq, D)),
        "k_cache": _w((lambda *s: torch.randn(*s, dtype=torch.bfloat16) * 0.8)(num_phys, bs, Hkv, D)),
        "v_cache": _w((lambda *s: torch.randn(*s, dtype=torch.bfloat16) * 0.05)(num_phys, bs, Hkv, D)),
        "block_table": _w(bt),
        "context_lens": _w(cl),
    }

def reference(q, k_cache, v_cache, block_table, context_lens):
    B, Hq, Sq, D = q.shape
    bs = k_cache.shape[1]
    Hkv = k_cache.shape[2]
    nbps = block_table.shape[1]
    Skv = nbps * bs
    bt = block_table.reshape(-1)
    k = (lambda x, *d: x.permute(*d))(k_cache[bt].reshape(B, Skv, Hkv, D), 0, 2, 1, 3)
    v = (lambda x, *d: x.permute(*d))(v_cache[bt].reshape(B, Skv, Hkv, D), 0, 2, 1, 3)
    g = Hq // Hkv
    qg = q.reshape(B, Hkv, g, Sq, D)
    scores = torch.einsum("bhgqd,bhkd->bhgqk", qg, k) * (D ** -0.5)
    pos = torch.arange(Skv)
    msk = pos[None, :] < context_lens[:, None]
    scores = torch.where(msk[:, None, None, None, :], scores, -1e9)
    p = _softmax(scores, axis=-1)
    out = torch.einsum("bhgqk,bhkd->bhgqd", p, v)
    return out.reshape(B, Hq, Sq, D)
```

```asm
; @launch grid=(256,1,1) block=(320,1,1) lds=161344
.amdgcn_target "amdgcn-amd-amdhsa--gfx950"
.text
.globl standalone__paged_block_table_kv_pagedattention__sampling_kernel
.p2align 8
.type standalone__paged_block_table_kv_pagedattention__sampling_kernel,@function
standalone__paged_block_table_kv_pagedattention__sampling_kernel:
    s_load_dwordx16 s[4:19], s[0:1], 0
    s_cmp_ge_u32 s2, 256
    s_cbranch_scc1 L_end
    s_getpc_b64 s[32:33]
L_pc0:
    v_lshlrev_b32 v4, 7, v0
    v_min_u32 v4, (L_code_end-L_pc0-4), v4
    global_load_dword v5, v4, s[32:33]
L_nocw:
    v_lshrrev_b32 v6, 6, v0
    v_and_b32 v0, 63, v0
    v_readfirstlane_b32 s36, v6
    s_and_b32 s37, s2, 7
    s_lshr_b32 s38, s2, 3
    v_lshlrev_b32 v7, 2, v0
    v_add_u32 v11, 156928, v7
    v_and_b32 v7, 28, v7
    v_lshrrev_b32 v16, 4, v0
    v_lshlrev_b32 v17, 2, v16
    v_xor_b32 v17, v17, v0
    v_and_b32 v17, 15, v17
    v_lshlrev_b32 v17, 4, v17
    v_lshl_add_u32 v8, v16, 11, v17
    s_mov_b32 s54, 0x40000
    s_mov_b32 s23, 0x20000
    s_mov_b32 s26, 3293184
    s_mov_b32 s27, 0x20000
    s_cmp_eq_u32 s36, 0
    s_cbranch_scc0 L_consumer
    s_setprio 3
    v_mov_b32 v10, 0
    ds_write_b32 v11, v10
    v_cmp_gt_u32 vcc, 4, v0
    v_lshlrev_b32 v16, 3, v0
    s_nop 0
    v_cndmask_b32 v16, 0, v16, vcc
    ds_write_b32 v11, v16 offset:256
    s_mov_b32 s22, 67239936
    s_lshl_b32 s70, s37, 8
    s_mov_b32 s65, 0
    s_mov_b32 s66, 0
    s_mov_b32 s67, 72
    v_and_b32 v28, 15, v0
    s_waitcnt lgkmcnt(0)
    global_load_dword v19, v7, s[12:13]
    s_mov_b32 s20, s6
    s_mov_b32 s21, s7
    s_mov_b32 s69, 0
    s_waitcnt vmcnt(0)
    v_add_u32 v1, -1, v19
    v_min_u32 v1, 0xfff, v1
    v_lshrrev_b32 v2, 2, v1
    v_add_u32 v2, 1, v2
    s_nop 1
    v_add_u32_dpp v3, v2, v2 row_shr:1 row_mask:0xf bank_mask:0xf bound_ctrl:1
    s_nop 1
    v_add_u32_dpp v3, v3, v3 row_shr:2 row_mask:0xf bank_mask:0xf bound_ctrl:1
    s_nop 1
    v_add_u32_dpp v3, v3, v3 row_shr:4 row_mask:0xf bank_mask:0xf bound_ctrl:1
    s_nop 0
    v_readlane_b32 s39, v3, 7
    s_cmp_le_u32 s39, 8131
    s_cselect_b32 s40, 7, 0
    s_cselect_b32 s50, 61, 0
    s_cselect_b32 s51, 49, 0
    s_add_u32 s51, s51, s39
    v_mad_u32_u24 v3, v0, s40, v3
    s_add_u32 s39, s39, s50
    s_mul_i32 s41, s38, s39
    s_add_u32 s42, s41, s39
    s_lshr_b32 s41, s41, 5
    v_cmp_ge_u32 vcc, s41, v3
    s_lshr_b32 s42, s42, 5
    s_min_u32 s42, s42, s51
    s_and_b32 s43, vcc_lo, 0xff
    s_bcnt1_i32_b32 s43, s43
    v_readlane_b32 s44, v3, s43
    v_readlane_b32 s45, v2, s43
    s_sub_u32 s46, s44, s45
    s_max_u32 s41, s41, s46
    s_sub_u32 s46, s41, s46
    s_min_u32 s47, s44, s42
    s_sub_u32 s48, s47, s41
    s_add_u32 s49, s48, 7
    s_lshr_b32 s49, s49, 3
    s_cmp_ge_u32 s41, s42
    s_cbranch_scc1 L_end
    s_barrier
L_lseg:
    s_lshl_b32 s68, s43, 10
    s_add_u32 s68, s68, s46
    v_add_u32 v16, s68, v28
    v_and_b32 v21, -4, v16
    v_add_u32 v21, 148736, v21
    ds_read_b32 v24, v21
    v_and_b32 v16, 3, v16
    v_lshl_add_u32 v23, v16, 13, s70
    s_sub_u32 s71, s48, 8
    s_waitcnt lgkmcnt(0)
    v_lshl_add_u32 v20, v24, 15, v23
L_lphase:
    v_mov_b32 v9, v20
    v_add_u32 v22, 16, v21
    s_mov_b32 s64, 0
L_lg0:
    s_add_u32 s65, s65, 8
    s_cmp_le_u32 s65, s67
    s_cbranch_scc0 L_lfree
L_lok0:
    s_cmp_gt_i32 s64, s71
    s_cbranch_scc1 L_lrem
    s_mov_b32 m0, s66
    v_add_u32_dpp v26, v9, v8 row_newbcast:0 row_mask:0xf bank_mask:0xf
    buffer_load_dwordx4 v26, s[20:23], 0 offen nt lds
    s_add_u32 m0, m0, 1040
    v_add_u32_dpp v27, v9, v8 row_newbcast:1 row_mask:0xf bank_mask:0xf
    ds_read_b32 v24, v22
    s_waitcnt vmcnt(22)
    buffer_load_dwordx4 v27, s[20:23], 0 offen nt lds
    s_add_u32 m0, m0, 1040
    v_add_u32_dpp v26, v9, v8 row_newbcast:2 row_mask:0xf bank_mask:0xf
    s_waitcnt vmcnt(22)
    buffer_load_dwordx4 v26, s[20:23], 0 offen nt lds
    s_add_u32 m0, m0, 1040
    v_add_u32_dpp v27, v9, v8 row_newbcast:3 row_mask:0xf bank_mask:0xf
    s_waitcnt vmcnt(22)
    buffer_load_dwordx4 v27, s[20:23], 0 offen nt lds
    s_add_u32 m0, m0, 1040
    v_add_u32_dpp v26, v9, v8 row_newbcast:4 row_mask:0xf bank_mask:0xf
    v_add_u32 v10, 4, v10
    s_waitcnt vmcnt(22)
    buffer_load_dwordx4 v26, s[20:23], 0 offen nt lds
    ds_max_u32 v11, v10
    s_add_u32 m0, m0, 1040
    v_add_u32_dpp v27, v9, v8 row_newbcast:5 row_mask:0xf bank_mask:0xf
    s_waitcnt vmcnt(22)
    buffer_load_dwordx4 v27, s[20:23], 0 offen nt lds
    s_add_u32 m0, m0, 1040
    v_add_u32_dpp v26, v9, v8 row_newbcast:6 row_mask:0xf bank_mask:0xf
    s_add_u32 s66, s66, 8320
    s_cmp_ge_u32 s66, 74880
    s_cselect_b32 s66, 0, s66
    s_waitcnt vmcnt(22)
    buffer_load_dwordx4 v26, s[20:23], 0 offen nt lds
    s_add_u32 m0, m0, 1040
    v_add_u32_dpp v27, v9, v8 row_newbcast:7 row_mask:0xf bank_mask:0xf
    s_waitcnt vmcnt(22)
    buffer_load_dwordx4 v27, s[20:23], 0 offen nt lds
    v_add_u32 v10, 4, v10
    s_add_u32 s64, s64, 8
    s_cmp_lt_u32 s64, s48
    s_waitcnt vmcnt(22)
    ds_max_u32 v11, v10
    s_cbranch_scc0 L_lphase_end
L_lg1:
    s_add_u32 s65, s65, 8
    s_cmp_le_u32 s65, s67
    s_cbranch_scc0 L_lfree
L_lok1:
    s_cmp_gt_i32 s64, s71
    s_cbranch_scc1 L_lrem
    s_mov_b32 m0, s66
    v_add_u32_dpp v26, v9, v8 row_newbcast:8 row_mask:0xf bank_mask:0xf
    buffer_load_dwordx4 v26, s[20:23], 0 offen nt lds
    s_add_u32 m0, m0, 1040
    v_add_u32_dpp v27, v9, v8 row_newbcast:9 row_mask:0xf bank_mask:0xf
    s_waitcnt vmcnt(22)
    buffer_load_dwordx4 v27, s[20:23], 0 offen nt lds
    s_add_u32 m0, m0, 1040
    v_add_u32_dpp v26, v9, v8 row_newbcast:10 row_mask:0xf bank_mask:0xf
    s_waitcnt vmcnt(22)
    buffer_load_dwordx4 v26, s[20:23], 0 offen nt lds
    s_add_u32 m0, m0, 1040
    v_add_u32_dpp v27, v9, v8 row_newbcast:11 row_mask:0xf bank_mask:0xf
    s_waitcnt lgkmcnt(0)
    v_lshl_add_u32 v25, v24, 15, v23
    v_add_u32 v22, 16, v22
    s_waitcnt vmcnt(22)
    buffer_load_dwordx4 v27, s[20:23], 0 offen nt lds
    s_add_u32 m0, m0, 1040
    v_add_u32_dpp v26, v9, v8 row_newbcast:12 row_mask:0xf bank_mask:0xf
    v_add_u32 v10, 4, v10
    s_waitcnt vmcnt(22)
    buffer_load_dwordx4 v26, s[20:23], 0 offen nt lds
    ds_max_u32 v11, v10
    s_add_u32 m0, m0, 1040
    v_add_u32_dpp v27, v9, v8 row_newbcast:13 row_mask:0xf bank_mask:0xf
    s_waitcnt vmcnt(22)
    buffer_load_dwordx4 v27, s[20:23], 0 offen nt lds
    s_add_u32 m0, m0, 1040
    v_add_u32_dpp v26, v9, v8 row_newbcast:14 row_mask:0xf bank_mask:0xf
    s_add_u32 s66, s66, 8320
    s_cmp_ge_u32 s66, 74880
    s_cselect_b32 s66, 0, s66
    s_waitcnt vmcnt(22)
    buffer_load_dwordx4 v26, s[20:23], 0 offen nt lds
    s_add_u32 m0, m0, 1040
    v_add_u32_dpp v27, v9, v8 row_newbcast:15 row_mask:0xf bank_mask:0xf
    s_waitcnt vmcnt(22)
    buffer_load_dwordx4 v27, s[20:23], 0 offen nt lds
    v_add_u32 v10, 4, v10
    v_mov_b32 v9, v25
    s_add_u32 s64, s64, 8
    s_cmp_lt_u32 s64, s48
    s_waitcnt vmcnt(22)
    ds_max_u32 v11, v10
    s_cbranch_scc1 L_lg0
    s_branch L_lphase_end
L_lrem:
    v_readlane_b32 s56, v9, s64
    s_sub_u32 s51, s48, s64
    v_add_u32 v10, s51, v10
    s_mov_b32 m0, s66
    s_add_u32 s64, s64, 1
L_lrem_loop:
    s_mov_b32 s57, s56
    v_readlane_b32 s56, v9, s64
    s_cmp_lt_u32 s64, s48
    buffer_load_dwordx4 v8, s[20:23], s57 offen nt lds
    s_addc_u32 s64, s64, 0
    s_add_u32 m0, m0, 1040
    s_sub_u32 s51, s51, 1
    s_cmp_lg_u32 s51, 0
    s_waitcnt vmcnt(22)
    s_cbranch_scc1 L_lrem_loop
    ds_max_u32 v11, v10
    s_mov_b32 s52, m0
    s_cmp_eq_u32 s69, 0
    s_cbranch_scc1 L_lzero_end
    v_mov_b64 v[12:13], 0
    v_mov_b64 v[14:15], 0
L_lzero:
    s_and_b32 s50, s64, 7
    s_cbranch_scc0 L_lzero_end
    v_lshl_add_u32 v16, v0, 4, s52
    ds_write_b128 v16, v[12:15]
    s_add_u32 s52, s52, 1040
    s_add_u32 s64, s64, 1
    s_branch L_lzero
L_lzero_end:
    s_add_u32 s66, s66, 8320
    s_cmp_ge_u32 s66, 74880
    s_cselect_b32 s66, 0, s66
L_lphase_end:
    s_cmp_eq_u32 s69, 0
    s_mov_b32 s69, 1
    s_mov_b32 s20, s8
    s_mov_b32 s21, s9
    s_cbranch_scc1 L_lphase
    s_add_u32 s41, s47, s40
    s_add_u32 s43, s43, 1
    s_cmp_lt_u32 s41, s42
    s_cbranch_scc1 L_lnext
    v_add_u32 v10, 1, v10
    s_waitcnt vmcnt(21)
    ds_max_u32 v11, v10
    v_add_u32 v10, 1, v10
    s_waitcnt vmcnt(20)
    ds_max_u32 v11, v10
    v_add_u32 v10, 1, v10
    s_waitcnt vmcnt(19)
    ds_max_u32 v11, v10
    v_add_u32 v10, 1, v10
    s_waitcnt vmcnt(18)
    ds_max_u32 v11, v10
    v_add_u32 v10, 1, v10
    s_waitcnt vmcnt(17)
    ds_max_u32 v11, v10
    v_add_u32 v10, 1, v10
    s_waitcnt vmcnt(16)
    ds_max_u32 v11, v10
    v_add_u32 v10, 1, v10
    s_waitcnt vmcnt(15)
    ds_max_u32 v11, v10
    v_add_u32 v10, 1, v10
    s_waitcnt vmcnt(14)
    ds_max_u32 v11, v10
    v_add_u32 v10, 1, v10
    s_waitcnt vmcnt(13)
    ds_max_u32 v11, v10
    v_add_u32 v10, 1, v10
    s_waitcnt vmcnt(12)
    ds_max_u32 v11, v10
    v_add_u32 v10, 1, v10
    s_waitcnt vmcnt(11)
    ds_max_u32 v11, v10
    v_add_u32 v10, 1, v10
    s_waitcnt vmcnt(10)
    ds_max_u32 v11, v10
    v_add_u32 v10, 1, v10
    s_waitcnt vmcnt(9)
    ds_max_u32 v11, v10
    v_add_u32 v10, 1, v10
    s_waitcnt vmcnt(8)
    ds_max_u32 v11, v10
    v_add_u32 v10, 1, v10
    s_waitcnt vmcnt(7)
    ds_max_u32 v11, v10
    v_add_u32 v10, 1, v10
    s_waitcnt vmcnt(6)
    ds_max_u32 v11, v10
    v_add_u32 v10, 1, v10
    s_waitcnt vmcnt(5)
    ds_max_u32 v11, v10
    v_add_u32 v10, 1, v10
    s_waitcnt vmcnt(4)
    ds_max_u32 v11, v10
    v_add_u32 v10, 1, v10
    s_waitcnt vmcnt(3)
    ds_max_u32 v11, v10
    v_add_u32 v10, 1, v10
    s_waitcnt vmcnt(2)
    ds_max_u32 v11, v10
    v_add_u32 v10, 1, v10
    s_waitcnt vmcnt(1)
    ds_max_u32 v11, v10
    v_add_u32 v10, 1, v10
    s_waitcnt vmcnt(0)
    ds_max_u32 v11, v10
    s_endpgm
L_lnext:
    s_mov_b32 s20, s6
    s_mov_b32 s21, s7
    s_mov_b32 s69, 0
    v_readlane_b32 s44, v3, s43
    v_readlane_b32 s45, v2, s43
    s_sub_u32 s46, s44, s45
    s_max_u32 s41, s41, s46
    s_sub_u32 s46, s41, s46
    s_min_u32 s47, s44, s42
    s_sub_u32 s48, s47, s41
    s_add_u32 s49, s48, 7
    s_lshr_b32 s49, s49, 3
    s_branch L_lseg
L_lfree:
    s_mov_b32 s53, 24
L_lfree1:
    v_mov_b32 v16, 156928
    ds_read_b128 v[16:19], v16 offset:256
    s_waitcnt lgkmcnt(0)
    v_min3_u32 v16, v16, v17, v18
    v_min_u32 v16, v16, v19
    s_nop 0
    v_readfirstlane_b32 s67, v16
    s_add_u32 s67, s67, 72
    s_cmp_le_u32 s65, s67
    s_cbranch_scc1 L_lfree_ok
    s_sub_u32 s53, s53, 1
    s_cbranch_scc0 L_lfree1
    v_add_u32 v16, 22, v10
    s_waitcnt vmcnt(0)
    ds_max_u32 v11, v16
L_lfree_spin:
    s_sub_u32 s54, s54, 1
    s_cbranch_scc1 L_end
    v_mov_b32 v16, 156928
    ds_read_b128 v[16:19], v16 offset:256
    s_waitcnt lgkmcnt(0)
    v_min3_u32 v16, v16, v17, v18
    v_min_u32 v16, v16, v19
    s_nop 0
    v_readfirstlane_b32 s67, v16
    s_add_u32 s67, s67, 72
    s_cmp_le_u32 s65, s67
    s_cbranch_scc0 L_lfree_spin
L_lfree_ok:
    s_bitcmp1_b32 s64, 3
    s_cbranch_scc1 L_lok1
    s_branch L_lok0
L_consumer:
    s_sub_u32 s64, s36, 1
    s_lshl_b32 s50, s64, 11
    s_add_u32 m0, s50, 148736
    v_lshlrev_b32 v244, 4, v0
    v_add_u32 v6, s50, v244
    v_lshl_add_u32 v250, v16, 8, v17
    s_mov_b32 s22, 524288
    s_mov_b32 s30, 524288
    s_mov_b32 s31, 0x20000
    s_waitcnt lgkmcnt(0)
    global_load_dword v19, v7, s[12:13]
    global_load_lds_dwordx4 v6, s[10:11]
    global_load_lds_dwordx4 v6, s[10:11] offset:1024
    s_mov_b32 s24, s18
    s_mov_b32 s25, s19
    s_cmp_eq_u32 s38, 31
    s_cbranch_scc0 L_notouch
    s_mul_i32 s50, s64, 9
    v_min_u32 v246, 8, v0
    v_add_u32 v246, s50, v246
    v_min_u32 v246, 32, v246
    v_lshlrev_b32 v246, 21, v246
    v_mov_b32 v249, 0
    global_load_dword v20, v246, s[6:7] sc1
    global_load_dword v21, v249, s[4:5] sc1
    global_load_dword v22, v249, s[16:17] sc1
    global_load_dword v23, v246, s[8:9] sc1
L_notouch:
    s_xor_b32 s50, s64, 2
    s_or_b32 s50, s2, s50
    s_cbranch_scc1 L_nolead
    s_memrealtime s[94:95]
    v_mov_b32 v246, 0
    s_waitcnt lgkmcnt(0)
    s_or_b32 s50, s94, 0x80000000
    v_mov_b32 v249, s50
    s_mov_b64 exec, 1
    global_store_dword v246, v249, s[16:17] sc1
    s_mov_b64 exec, -1
L_nolead:
    s_mov_b32 s20, s4
    s_mov_b32 s21, s5
    s_mov_b32 s28, s14
    s_mov_b32 s29, s15
    s_mov_b32 s76, 1040356334
    s_mov_b32 s65, 0
    s_mov_b32 s72, 22
    s_mov_b32 s73, 0
    s_mov_b32 s74, 0
    s_mov_b32 s75, 0
    v_bfe_u32 v84, v0, 2, 3
    v_mul_u32_u24 v84, 1040, v84
    v_and_b32 v85, 3, v0
    v_lshl_add_u32 v84, v85, 8, v84
    v_lshrrev_b32 v86, 5, v0
    v_lshl_add_u32 v84, v86, 4, v84
    v_lshlrev_b32 v88, 6, v85
    v_mul_u32_u24 v8, 1040, v86
    v_bfe_u32 v87, v0, 2, 2
    v_lshl_add_u32 v8, v87, 8, v8
    v_xor_b32 v87, s64, v87
    v_lshl_add_u32 v8, v87, 6, v8
    v_bfe_u32 v87, v0, 4, 1
    v_lshl_add_u32 v8, v87, 5, v8
    v_lshl_add_u32 v8, v85, 3, v8
    v_add_u32 v9, 83200, v244
    v_mov_b32 v14, 156928
    s_lshl_b32 s50, s64, 2
    v_add_u32 v15, s50, v14
    v_and_b32 v87, 31, v0
    v_lshl_add_u32 v17, v87, 4, v14
    v_add_u32 v16, s50, v17
    v_mov_b32 v18, 0xff800000
    s_cmp_eq_u32 s38, 31
    s_waitcnt vmcnt(4)
    s_cbranch_scc1 L_twait
    s_xor_b32 s50, s64, 2
    s_or_b32 s50, s2, s50
    s_waitcnt vmcnt(1)
    s_cbranch_scc0 L_twait
    s_waitcnt vmcnt(0)
L_twait:
    v_xor_b32 v87, 0, v88
    v_add_u32 v4, v87, v84
    v_xor_b32 v87, 64, v88
    v_add_u32 v5, v87, v84
    v_xor_b32 v87, 128, v88
    v_add_u32 v6, v87, v84
    v_xor_b32 v87, 192, v88
    v_add_u32 v7, v87, v84
    v_add_u32 v1, -1, v19
    v_min_u32 v1, 0xfff, v1
    v_lshrrev_b32 v2, 2, v1
    v_add_u32 v2, 1, v2
    v_cmp_gt_i32 s[34:35], 1, v19
    s_nop 0
    v_add_u32_dpp v3, v2, v2 row_shr:1 row_mask:0xf bank_mask:0xf bound_ctrl:1
    s_nop 1
    v_add_u32_dpp v3, v3, v3 row_shr:2 row_mask:0xf bank_mask:0xf bound_ctrl:1
    s_nop 1
    v_add_u32_dpp v3, v3, v3 row_shr:4 row_mask:0xf bank_mask:0xf bound_ctrl:1
    s_nop 0
    v_readlane_b32 s39, v3, 7
    s_cmp_le_u32 s39, 8131
    s_cselect_b32 s40, 7, 0
    s_cselect_b32 s50, 61, 0
    s_cselect_b32 s51, 49, 0
    s_add_u32 s51, s51, s39
    v_mad_u32_u24 v3, v0, s40, v3
    s_add_u32 s39, s39, s50
    s_mul_i32 s41, s38, s39
    s_add_u32 s42, s41, s39
    s_lshr_b32 s41, s41, 5
    v_cmp_ge_u32 vcc, s41, v3
    s_lshr_b32 s42, s42, 5
    s_min_u32 s42, s42, s51
    s_and_b32 s43, vcc_lo, 0xff
    s_bcnt1_i32_b32 s43, s43
    v_readlane_b32 s44, v3, s43
    v_readlane_b32 s45, v2, s43
    s_sub_u32 s46, s44, s45
    s_max_u32 s41, s41, s46
    s_sub_u32 s46, s41, s46
    s_min_u32 s47, s44, s42
    s_sub_u32 s48, s47, s41
    s_add_u32 s49, s48, 7
    s_lshr_b32 s49, s49, 3
    s_cmp_ge_u32 s41, s42
    s_cbranch_scc1 L_end
    s_barrier
    s_cmp_eq_u32 s64, 0
    s_cbranch_scc0 L_noq0
    s_lshl_b32 s50, s43, 16
    s_lshl_b32 s51, s37, 13
    s_add_u32 s50, s50, s51
    s_mov_b32 m0, 74880
    s_nop 0
    buffer_load_dwordx4 v250, s[20:23], s50 offen lds
    s_add_u32 m0, m0, 1040
    s_add_u32 s50, s50, 1024
    buffer_load_dwordx4 v250, s[20:23], s50 offen lds
    s_add_u32 m0, m0, 1040
    s_add_u32 s50, s50, 1024
    buffer_load_dwordx4 v250, s[20:23], s50 offen lds
    s_add_u32 m0, m0, 1040
    s_add_u32 s50, s50, 1024
    buffer_load_dwordx4 v250, s[20:23], s50 offen lds
    s_add_u32 m0, m0, 1040
    s_add_u32 s50, s50, 1024
    buffer_load_dwordx4 v250, s[20:23], s50 offen lds
    s_add_u32 m0, m0, 1040
    s_add_u32 s50, s50, 1024
    buffer_load_dwordx4 v250, s[20:23], s50 offen lds
    s_add_u32 m0, m0, 1040
    s_add_u32 s50, s50, 1024
    buffer_load_dwordx4 v250, s[20:23], s50 offen lds
    s_add_u32 m0, m0, 1040
    s_add_u32 s50, s50, 1024
    buffer_load_dwordx4 v250, s[20:23], s50 offen lds
L_noq0:
    s_waitcnt vmcnt(0)
    s_cmp_eq_u32 s64, 0
    s_cbranch_scc0 L_noq1
    s_mov_b32 s50, 1
    v_mov_b32 v249, s50
    s_mov_b64 exec, 1
    ds_write_b32 v15, v249 offset:288
    s_mov_b64 exec, -1
L_noq1:
    s_getreg_b32 s32, hwreg(HW_REG_XCC_ID, 0, 4)
    s_cmp_eq_u32 s64, 3
    s_cbranch_scc1 L_getnon
L_cseg:
    v_readlane_b32 s77, v1, s43
    s_add_u32 s75, s75, 1
L_qwait:
    s_sub_u32 s54, s54, 1
    s_cbranch_scc1 L_end
    ds_read_b32 v19, v14 offset:288
    s_waitcnt lgkmcnt(0)
    v_readfirstlane_b32 s50, v19
    s_cmp_ge_u32 s50, s75
    s_cbranch_scc0 L_qwait
    v_add_u32 v244, 74880, v4
    v_add_u32 v245, 74880, v5
    v_add_u32 v246, 74880, v6
    v_add_u32 v247, 74880, v7
    ds_read_b128 v[20:23], v244
    ds_read_b128 v[24:27], v244 offset:32
    ds_read_b128 v[28:31], v245
    ds_read_b128 v[32:35], v245 offset:32
    ds_read_b128 v[36:39], v246
    ds_read_b128 v[40:43], v246 offset:32
    ds_read_b128 v[44:47], v247
    ds_read_b128 v[48:51], v247 offset:32
    s_lshl_b32 s50, s46, 2
    s_sub_u32 s77, s77, s50
    s_add_u32 s77, s77, 1
    s_lshl_b32 s50, s48, 2
    s_min_u32 s77, s77, s50
    s_sub_u32 s71, s49, 1
    s_mov_b32 s70, s64
    s_lshl_b32 s51, s64, 3
    s_add_u32 s66, s72, s51
    s_add_u32 s66, s66, 8
    s_add_u32 s68, s73, s51
    s_add_u32 s68, s68, 32
    s_lshl_b32 s51, s49, 3
    s_add_u32 s69, s73, s51
    s_mul_i32 s67, s64, 8320
    s_add_u32 s67, s67, s74
    s_cmp_ge_u32 s67, 74880
    s_cselect_b32 s50, 74880, 0
    s_sub_u32 s67, s67, s50
    s_cmp_ge_u32 s49, 5
    s_cselect_b32 s60, 1, 0
    v_mov_b32 v11, v18
    v_mov_b32 v12, 0
    v_mov_b32 v13, 0
    s_lshl_b32 s50, s64, 11
    v_add_u32 v248, s50, v9
    s_bitcmp1_b32 s34, s43
    s_waitcnt lgkmcnt(0)
    s_cbranch_scc0 L_nozq
    v_mov_b64 v[20:21], 0
    v_mov_b64 v[22:23], 0
    v_mov_b64 v[24:25], 0
    v_mov_b64 v[26:27], 0
    v_mov_b64 v[28:29], 0
    v_mov_b64 v[30:31], 0
    v_mov_b64 v[32:33], 0
    v_mov_b64 v[34:35], 0
    v_mov_b64 v[36:37], 0
    v_mov_b64 v[38:39], 0
    v_mov_b64 v[40:41], 0
    v_mov_b64 v[42:43], 0
    v_mov_b64 v[44:45], 0
    v_mov_b64 v[46:47], 0
    v_mov_b64 v[48:49], 0
    v_mov_b64 v[50:51], 0
L_nozq:
    s_cmp_ge_u32 s70, s71
    s_cbranch_scc1 L_klast
    s_cmp_ge_u32 s65, s66
    s_cbranch_scc1 L_go_1
L_poll_2:
    s_sub_u32 s54, s54, 1
    s_cbranch_scc1 L_end
    ds_read_b32 v19, v14
    s_waitcnt lgkmcnt(0)
    v_readfirstlane_b32 s65, v19
    s_cmp_ge_u32 s65, s66
    s_cbranch_scc0 L_poll_2
L_go_1:
    v_add_u32 v244, s67, v4
    v_add_u32 v245, s67, v5
    v_add_u32 v246, s67, v6
    v_add_u32 v247, s67, v7
    ds_read_b128 v[52:55], v244
    ds_read_b128 v[56:59], v244 offset:32
    ds_read_b128 v[60:63], v245
    ds_read_b128 v[64:67], v245 offset:32
    ds_read_b128 v[68:71], v246
    ds_read_b128 v[72:75], v246 offset:32
    ds_read_b128 v[76:79], v247
    ds_read_b128 v[80:83], v247 offset:32
    s_waitcnt lgkmcnt(7)
    v_mfma_f32_32x32x16_bf16 v[100:115], v[52:55], v[20:23], 0
    s_waitcnt lgkmcnt(6)
    v_mfma_f32_32x32x16_bf16 v[100:115], v[56:59], v[24:27], v[100:115]
    s_waitcnt lgkmcnt(5)
    v_mfma_f32_32x32x16_bf16 v[100:115], v[60:63], v[28:31], v[100:115]
    s_waitcnt lgkmcnt(4)
    v_mfma_f32_32x32x16_bf16 v[100:115], v[64:67], v[32:35], v[100:115]
    s_waitcnt lgkmcnt(3)
    v_mfma_f32_32x32x16_bf16 v[100:115], v[68:71], v[36:39], v[100:115]
    s_waitcnt lgkmcnt(2)
    v_mfma_f32_32x32x16_bf16 v[100:115], v[72:75], v[40:43], v[100:115]
    s_waitcnt lgkmcnt(1)
    v_mfma_f32_32x32x16_bf16 v[100:115], v[76:79], v[44:47], v[100:115]
    s_waitcnt lgkmcnt(0)
    v_mfma_f32_32x32x16_bf16 v[100:115], v[80:83], v[48:51], v[100:115]
    s_min_u32 s51, s68, s69
    v_mov_b32 v249, s51
    s_mov_b64 exec, 1
    ds_write_b32 v15, v249 offset:256
    s_mov_b64 exec, -1
    s_add_u32 s70, s70, 4
    s_add_u32 s66, s66, 32
    s_add_u32 s68, s68, 32
    s_add_u32 s67, s67, 33280
    s_cmp_ge_u32 s67, 74880
    s_cselect_b32 s50, 74880, 0
    s_sub_u32 s67, s67, s50
    s_nop 0
    v_max3_f32 v11, v11, v100, v101
    v_max3_f32 v11, v11, v102, v103
    v_max3_f32 v11, v11, v104, v105
    v_max3_f32 v11, v11, v106, v107
    v_max3_f32 v11, v11, v108, v109
    v_max3_f32 v11, v11, v110, v111
    v_max3_f32 v11, v11, v112, v113
    v_max3_f32 v11, v11, v114, v115
    s_cmp_eq_u32 s60, 0
    s_cbranch_scc1 L_klast
    v_mov_b32 v251, v11
    v_mov_b32 v19, v11
    s_nop 1
    v_permlane32_swap_b32 v251, v19
    v_max_f32 v251, v251, v19
    s_add_u32 s75, s75, 1
    v_mov_b32 v249, s75
    s_mov_b32 exec_hi, 0
    ds_write_b32 v16, v251 offset:320
    s_mov_b64 exec, 1
    ds_write_b32 v15, v249 offset:272
    s_mov_b64 exec, -1
L_sync_3:
    s_sub_u32 s54, s54, 1
    s_cbranch_scc1 L_end
    ds_read_b128 v[60:63], v14 offset:272
    ds_read_b128 v[52:55], v17 offset:320
    s_waitcnt lgkmcnt(0)
    v_min3_u32 v60, v60, v61, v62
    v_min_u32 v60, v60, v63
    s_nop 0
    v_readfirstlane_b32 s50, v60
    s_cmp_ge_u32 s50, s75
    s_cbranch_scc0 L_sync_3
    v_max3_f32 v251, v52, v53, v54
    v_max_f32 v251, v251, v55
    v_mul_f32 v251, s76, v251
    v_fma_f32 v68, v100, s76, -v251
    v_fma_f32 v69, v101, s76, -v251
    v_fma_f32 v70, v102, s76, -v251
    v_fma_f32 v71, v103, s76, -v251
    v_fma_f32 v72, v104, s76, -v251
    v_fma_f32 v73, v105, s76, -v251
    v_fma_f32 v74, v106, s76, -v251
    v_fma_f32 v75, v107, s76, -v251
    v_fma_f32 v76, v108, s76, -v251
    v_fma_f32 v77, v109, s76, -v251
    v_fma_f32 v78, v110, s76, -v251
    v_fma_f32 v79, v111, s76, -v251
    v_fma_f32 v80, v112, s76, -v251
    v_fma_f32 v81, v113, s76, -v251
    v_fma_f32 v82, v114, s76, -v251
    v_fma_f32 v83, v115, s76, -v251
    v_exp_f32 v68, v68
    v_exp_f32 v69, v69
    v_exp_f32 v70, v70
    v_exp_f32 v71, v71
    v_exp_f32 v72, v72
    v_exp_f32 v73, v73
    v_exp_f32 v74, v74
    v_exp_f32 v75, v75
    v_exp_f32 v76, v76
    v_exp_f32 v77, v77
    v_exp_f32 v78, v78
    v_exp_f32 v79, v79
    v_exp_f32 v80, v80
    v_exp_f32 v81, v81
    v_exp_f32 v82, v82
    v_exp_f32 v83, v83
    v_add_f32 v12, v12, v68
    v_add_f32 v13, v13, v69
    v_cvt_pk_bf16_f32 v52, v68, v69
    v_add_f32 v12, v12, v70
    v_add_f32 v13, v13, v71
    v_cvt_pk_bf16_f32 v53, v70, v71
    v_add_f32 v12, v12, v72
    v_add_f32 v13, v13, v73
    v_cvt_pk_bf16_f32 v54, v72, v73
    v_add_f32 v12, v12, v74
    v_add_f32 v13, v13, v75
    v_cvt_pk_bf16_f32 v55, v74, v75
    v_add_f32 v12, v12, v76
    v_add_f32 v13, v13, v77
    v_cvt_pk_bf16_f32 v56, v76, v77
    v_add_f32 v12, v12, v78
    v_add_f32 v13, v13, v79
    v_cvt_pk_bf16_f32 v57, v78, v79
    v_add_f32 v12, v12, v80
    v_add_f32 v13, v13, v81
    v_cvt_pk_bf16_f32 v58, v80, v81
    v_add_f32 v12, v12, v82
    v_add_f32 v13, v13, v83
    v_cvt_pk_bf16_f32 v59, v82, v83
    ds_write_b128 v248, v[52:55]
    ds_write_b128 v248, v[56:59] offset:1024
    v_add_u32 v248, 8192, v248
    s_cmp_ge_u32 s70, s71
    s_cbranch_scc1 L_klast
    s_cmp_ge_u32 s65, s66
    s_cbranch_scc1 L_go_4
L_poll_5:
    s_sub_u32 s54, s54, 1
    s_cbranch_scc1 L_end
    ds_read_b32 v19, v14
    s_waitcnt lgkmcnt(0)
    v_readfirstlane_b32 s65, v19
    s_cmp_ge_u32 s65, s66
    s_cbranch_scc0 L_poll_5
L_go_4:
    v_add_u32 v244, s67, v4
    v_add_u32 v245, s67, v5
    v_add_u32 v246, s67, v6
    v_add_u32 v247, s67, v7
    ds_read_b128 v[52:55], v244
    ds_read_b128 v[56:59], v244 offset:32
    ds_read_b128 v[60:63], v245
    ds_read_b128 v[64:67], v245 offset:32
    ds_read_b128 v[68:71], v246
    ds_read_b128 v[72:75], v246 offset:32
    ds_read_b128 v[76:79], v247
    ds_read_b128 v[80:83], v247 offset:32
    s_waitcnt lgkmcnt(7)
    v_mfma_f32_32x32x16_bf16 v[116:131], v[52:55], v[20:23], 0
    s_waitcnt lgkmcnt(6)
    v_mfma_f32_32x32x16_bf16 v[116:131], v[56:59], v[24:27], v[116:131]
    s_waitcnt lgkmcnt(5)
    v_mfma_f32_32x32x16_bf16 v[116:131], v[60:63], v[28:31], v[116:131]
    s_waitcnt lgkmcnt(4)
    v_mfma_f32_32x32x16_bf16 v[116:131], v[64:67], v[32:35], v[116:131]
    s_waitcnt lgkmcnt(3)
    v_mfma_f32_32x32x16_bf16 v[116:131], v[68:71], v[36:39], v[116:131]
    s_waitcnt lgkmcnt(2)
    v_mfma_f32_32x32x16_bf16 v[116:131], v[72:75], v[40:43], v[116:131]
    s_waitcnt lgkmcnt(1)
    v_mfma_f32_32x32x16_bf16 v[116:131], v[76:79], v[44:47], v[116:131]
    s_waitcnt lgkmcnt(0)
    v_mfma_f32_32x32x16_bf16 v[116:131], v[80:83], v[48:51], v[116:131]
    s_min_u32 s51, s68, s69
    v_mov_b32 v249, s51
    s_mov_b64 exec, 1
    ds_write_b32 v15, v249 offset:256
    s_mov_b64 exec, -1
    s_add_u32 s70, s70, 4
    s_add_u32 s66, s66, 32
    s_add_u32 s68, s68, 32
    s_add_u32 s67, s67, 33280
    s_cmp_ge_u32 s67, 74880
    s_cselect_b32 s50, 74880, 0
    s_sub_u32 s67, s67, s50
    s_nop 0
    v_max3_f32 v11, v11, v116, v117
    v_max3_f32 v11, v11, v118, v119
    v_max3_f32 v11, v11, v120, v121
    v_max3_f32 v11, v11, v122, v123
    v_max3_f32 v11, v11, v124, v125
    v_max3_f32 v11, v11, v126, v127
    v_max3_f32 v11, v11, v128, v129
    v_max3_f32 v11, v11, v130, v131
    v_fma_f32 v68, v116, s76, -v251
    v_fma_f32 v69, v117, s76, -v251
    v_fma_f32 v70, v118, s76, -v251
    v_fma_f32 v71, v119, s76, -v251
    v_fma_f32 v72, v120, s76, -v251
    v_fma_f32 v73, v121, s76, -v251
    v_fma_f32 v74, v122, s76, -v251
    v_fma_f32 v75, v123, s76, -v251
    v_fma_f32 v76, v124, s76, -v251
    v_fma_f32 v77, v125, s76, -v251
    v_fma_f32 v78, v126, s76, -v251
    v_fma_f32 v79, v127, s76, -v251
    v_fma_f32 v80, v128, s76, -v251
    v_fma_f32 v81, v129, s76, -v251
    v_fma_f32 v82, v130, s76, -v251
    v_fma_f32 v83, v131, s76, -v251
    v_exp_f32 v68, v68
    v_exp_f32 v69, v69
    v_exp_f32 v70, v70
    v_exp_f32 v71, v71
    v_exp_f32 v72, v72
    v_exp_f32 v73, v73
    v_exp_f32 v74, v74
    v_exp_f32 v75, v75
    v_exp_f32 v76, v76
    v_exp_f32 v77, v77
    v_exp_f32 v78, v78
    v_exp_f32 v79, v79
    v_exp_f32 v80, v80
    v_exp_f32 v81, v81
    v_exp_f32 v82, v82
    v_exp_f32 v83, v83
    v_add_f32 v12, v12, v68
    v_add_f32 v13, v13, v69
    v_cvt_pk_bf16_f32 v52, v68, v69
    v_add_f32 v12, v12, v70
    v_add_f32 v13, v13, v71
    v_cvt_pk_bf16_f32 v53, v70, v71
    v_add_f32 v12, v12, v72
    v_add_f32 v13, v13, v73
    v_cvt_pk_bf16_f32 v54, v72, v73
    v_add_f32 v12, v12, v74
    v_add_f32 v13, v13, v75
    v_cvt_pk_bf16_f32 v55, v74, v75
    v_add_f32 v12, v12, v76
    v_add_f32 v13, v13, v77
    v_cvt_pk_bf16_f32 v56, v76, v77
    v_add_f32 v12, v12, v78
    v_add_f32 v13, v13, v79
    v_cvt_pk_bf16_f32 v57, v78, v79
    v_add_f32 v12, v12, v80
    v_add_f32 v13, v13, v81
    v_cvt_pk_bf16_f32 v58, v80, v81
    v_add_f32 v12, v12, v82
    v_add_f32 v13, v13, v83
    v_cvt_pk_bf16_f32 v59, v82, v83
    ds_write_b128 v248, v[52:55]
    ds_write_b128 v248, v[56:59] offset:1024
    v_add_u32 v248, 8192, v248
    s_cmp_ge_u32 s70, s71
    s_cbranch_scc1 L_klast
    s_cmp_ge_u32 s65, s66
    s_cbranch_scc1 L_go_6
L_poll_7:
    s_sub_u32 s54, s54, 1
    s_cbranch_scc1 L_end
    ds_read_b32 v19, v14
    s_waitcnt lgkmcnt(0)
    v_readfirstlane_b32 s65, v19
    s_cmp_ge_u32 s65, s66
    s_cbranch_scc0 L_poll_7
L_go_6:
    v_add_u32 v244, s67, v4
    v_add_u32 v245, s67, v5
    v_add_u32 v246, s67, v6
    v_add_u32 v247, s67, v7
    ds_read_b128 v[52:55], v244
    ds_read_b128 v[56:59], v244 offset:32
    ds_read_b128 v[60:63], v245
    ds_read_b128 v[64:67], v245 offset:32
    ds_read_b128 v[68:71], v246
    ds_read_b128 v[72:75], v246 offset:32
    ds_read_b128 v[76:79], v247
    ds_read_b128 v[80:83], v247 offset:32
    s_waitcnt lgkmcnt(7)
    v_mfma_f32_32x32x16_bf16 v[132:147], v[52:55], v[20:23], 0
    s_waitcnt lgkmcnt(6)
    v_mfma_f32_32x32x16_bf16 v[132:147], v[56:59], v[24:27], v[132:147]
    s_waitcnt lgkmcnt(5)
    v_mfma_f32_32x32x16_bf16 v[132:147], v[60:63], v[28:31], v[132:147]
    s_waitcnt lgkmcnt(4)
    v_mfma_f32_32x32x16_bf16 v[132:147], v[64:67], v[32:35], v[132:147]
    s_waitcnt lgkmcnt(3)
    v_mfma_f32_32x32x16_bf16 v[132:147], v[68:71], v[36:39], v[132:147]
    s_waitcnt lgkmcnt(2)
    v_mfma_f32_32x32x16_bf16 v[132:147], v[72:75], v[40:43], v[132:147]
    s_waitcnt lgkmcnt(1)
    v_mfma_f32_32x32x16_bf16 v[132:147], v[76:79], v[44:47], v[132:147]
    s_waitcnt lgkmcnt(0)
    v_mfma_f32_32x32x16_bf16 v[132:147], v[80:83], v[48:51], v[132:147]
    s_min_u32 s51, s68, s69
    v_mov_b32 v249, s51
    s_mov_b64 exec, 1
    ds_write_b32 v15, v249 offset:256
    s_mov_b64 exec, -1
    s_add_u32 s70, s70, 4
    s_add_u32 s66, s66, 32
    s_add_u32 s68, s68, 32
    s_add_u32 s67, s67, 33280
    s_cmp_ge_u32 s67, 74880
    s_cselect_b32 s50, 74880, 0
    s_sub_u32 s67, s67, s50
    s_nop 0
    v_max3_f32 v11, v11, v132, v133
    v_max3_f32 v11, v11, v134, v135
    v_max3_f32 v11, v11, v136, v137
    v_max3_f32 v11, v11, v138, v139
    v_max3_f32 v11, v11, v140, v141
    v_max3_f32 v11, v11, v142, v143
    v_max3_f32 v11, v11, v144, v145
    v_max3_f32 v11, v11, v146, v147
    v_fma_f32 v68, v132, s76, -v251
    v_fma_f32 v69, v133, s76, -v251
    v_fma_f32 v70, v134, s76, -v251
    v_fma_f32 v71, v135, s76, -v251
    v_fma_f32 v72, v136, s76, -v251
    v_fma_f32 v73, v137, s76, -v251
    v_fma_f32 v74, v138, s76, -v251
    v_fma_f32 v75, v139, s76, -v251
    v_fma_f32 v76, v140, s76, -v251
    v_fma_f32 v77, v141, s76, -v251
    v_fma_f32 v78, v142, s76, -v251
    v_fma_f32 v79, v143, s76, -v251
    v_fma_f32 v80, v144, s76, -v251
    v_fma_f32 v81, v145, s76, -v251
    v_fma_f32 v82, v146, s76, -v251
    v_fma_f32 v83, v147, s76, -v251
    v_exp_f32 v68, v68
    v_exp_f32 v69, v69
    v_exp_f32 v70, v70
    v_exp_f32 v71, v71
    v_exp_f32 v72, v72
    v_exp_f32 v73, v73
    v_exp_f32 v74, v74
    v_exp_f32 v75, v75
    v_exp_f32 v76, v76
    v_exp_f32 v77, v77
    v_exp_f32 v78, v78
    v_exp_f32 v79, v79
    v_exp_f32 v80, v80
    v_exp_f32 v81, v81
    v_exp_f32 v82, v82
    v_exp_f32 v83, v83
    v_add_f32 v12, v12, v68
    v_add_f32 v13, v13, v69
    v_cvt_pk_bf16_f32 v52, v68, v69
    v_add_f32 v12, v12, v70
    v_add_f32 v13, v13, v71
    v_cvt_pk_bf16_f32 v53, v70, v71
    v_add_f32 v12, v12, v72
    v_add_f32 v13, v13, v73
    v_cvt_pk_bf16_f32 v54, v72, v73
    v_add_f32 v12, v12, v74
    v_add_f32 v13, v13, v75
    v_cvt_pk_bf16_f32 v55, v74, v75
    v_add_f32 v12, v12, v76
    v_add_f32 v13, v13, v77
    v_cvt_pk_bf16_f32 v56, v76, v77
    v_add_f32 v12, v12, v78
    v_add_f32 v13, v13, v79
    v_cvt_pk_bf16_f32 v57, v78, v79
    v_add_f32 v12, v12, v80
    v_add_f32 v13, v13, v81
    v_cvt_pk_bf16_f32 v58, v80, v81
    v_add_f32 v12, v12, v82
    v_add_f32 v13, v13, v83
    v_cvt_pk_bf16_f32 v59, v82, v83
    ds_write_b128 v248, v[52:55]
    ds_write_b128 v248, v[56:59] offset:1024
    v_add_u32 v248, 8192, v248
    s_cmp_ge_u32 s70, s71
    s_cbranch_scc1 L_klast
    s_cmp_ge_u32 s65, s66
    s_cbranch_scc1 L_go_8
L_poll_9:
    s_sub_u32 s54, s54, 1
    s_cbranch_scc1 L_end
    ds_read_b32 v19, v14
    s_waitcnt lgkmcnt(0)
    v_readfirstlane_b32 s65, v19
    s_cmp_ge_u32 s65, s66
    s_cbranch_scc0 L_poll_9
L_go_8:
    v_add_u32 v244, s67, v4
    v_add_u32 v245, s67, v5
    v_add_u32 v246, s67, v6
    v_add_u32 v247, s67, v7
    ds_read_b128 v[52:55], v244
    ds_read_b128 v[56:59], v244 offset:32
    ds_read_b128 v[60:63], v245
    ds_read_b128 v[64:67], v245 offset:32
    ds_read_b128 v[68:71], v246
    ds_read_b128 v[72:75], v246 offset:32
    ds_read_b128 v[76:79], v247
    ds_read_b128 v[80:83], v247 offset:32
    s_waitcnt lgkmcnt(7)
    v_mfma_f32_32x32x16_bf16 v[148:163], v[52:55], v[20:23], 0
    s_waitcnt lgkmcnt(6)
    v_mfma_f32_32x32x16_bf16 v[148:163], v[56:59], v[24:27], v[148:163]
    s_waitcnt lgkmcnt(5)
    v_mfma_f32_32x32x16_bf16 v[148:163], v[60:63], v[28:31], v[148:163]
    s_waitcnt lgkmcnt(4)
    v_mfma_f32_32x32x16_bf16 v[148:163], v[64:67], v[32:35], v[148:163]
    s_waitcnt lgkmcnt(3)
    v_mfma_f32_32x32x16_bf16 v[148:163], v[68:71], v[36:39], v[148:163]
    s_waitcnt lgkmcnt(2)
    v_mfma_f32_32x32x16_bf16 v[148:163], v[72:75], v[40:43], v[148:163]
    s_waitcnt lgkmcnt(1)
    v_mfma_f32_32x32x16_bf16 v[148:163], v[76:79], v[44:47], v[148:163]
    s_waitcnt lgkmcnt(0)
    v_mfma_f32_32x32x16_bf16 v[148:163], v[80:83], v[48:51], v[148:163]
    s_min_u32 s51, s68, s69
    v_mov_b32 v249, s51
    s_mov_b64 exec, 1
    ds_write_b32 v15, v249 offset:256
    s_mov_b64 exec, -1
    s_add_u32 s70, s70, 4
    s_add_u32 s66, s66, 32
    s_add_u32 s68, s68, 32
    s_add_u32 s67, s67, 33280
    s_cmp_ge_u32 s67, 74880
    s_cselect_b32 s50, 74880, 0
    s_sub_u32 s67, s67, s50
    s_nop 0
    v_max3_f32 v11, v11, v148, v149
    v_max3_f32 v11, v11, v150, v151
    v_max3_f32 v11, v11, v152, v153
    v_max3_f32 v11, v11, v154, v155
    v_max3_f32 v11, v11, v156, v157
    v_max3_f32 v11, v11, v158, v159
    v_max3_f32 v11, v11, v160, v161
    v_max3_f32 v11, v11, v162, v163
    v_fma_f32 v68, v148, s76, -v251
    v_fma_f32 v69, v149, s76, -v251
    v_fma_f32 v70, v150, s76, -v251
    v_fma_f32 v71, v151, s76, -v251
    v_fma_f32 v72, v152, s76, -v251
    v_fma_f32 v73, v153, s76, -v251
    v_fma_f32 v74, v154, s76, -v251
    v_fma_f32 v75, v155, s76, -v251
    v_fma_f32 v76, v156, s76, -v251
    v_fma_f32 v77, v157, s76, -v251
    v_fma_f32 v78, v158, s76, -v251
    v_fma_f32 v79, v159, s76, -v251
    v_fma_f32 v80, v160, s76, -v251
    v_fma_f32 v81, v161, s76, -v251
    v_fma_f32 v82, v162, s76, -v251
    v_fma_f32 v83, v163, s76, -v251
    v_exp_f32 v68, v68
    v_exp_f32 v69, v69
    v_exp_f32 v70, v70
    v_exp_f32 v71, v71
    v_exp_f32 v72, v72
    v_exp_f32 v73, v73
    v_exp_f32 v74, v74
    v_exp_f32 v75, v75
    v_exp_f32 v76, v76
    v_exp_f32 v77, v77
    v_exp_f32 v78, v78
    v_exp_f32 v79, v79
    v_exp_f32 v80, v80
    v_exp_f32 v81, v81
    v_exp_f32 v82, v82
    v_exp_f32 v83, v83
    v_add_f32 v12, v12, v68
    v_add_f32 v13, v13, v69
    v_cvt_pk_bf16_f32 v52, v68, v69
    v_add_f32 v12, v12, v70
    v_add_f32 v13, v13, v71
    v_cvt_pk_bf16_f32 v53, v70, v71
    v_add_f32 v12, v12, v72
    v_add_f32 v13, v13, v73
    v_cvt_pk_bf16_f32 v54, v72, v73
    v_add_f32 v12, v12, v74
    v_add_f32 v13, v13, v75
    v_cvt_pk_bf16_f32 v55, v74, v75
    v_add_f32 v12, v12, v76
    v_add_f32 v13, v13, v77
    v_cvt_pk_bf16_f32 v56, v76, v77
    v_add_f32 v12, v12, v78
    v_add_f32 v13, v13, v79
    v_cvt_pk_bf16_f32 v57, v78, v79
    v_add_f32 v12, v12, v80
    v_add_f32 v13, v13, v81
    v_cvt_pk_bf16_f32 v58, v80, v81
    v_add_f32 v12, v12, v82
    v_add_f32 v13, v13, v83
    v_cvt_pk_bf16_f32 v59, v82, v83
    ds_write_b128 v248, v[52:55]
    ds_write_b128 v248, v[56:59] offset:1024
    v_add_u32 v248, 8192, v248
    s_cmp_ge_u32 s70, s71
    s_cbranch_scc1 L_klast
    s_cmp_ge_u32 s65, s66
    s_cbranch_scc1 L_go_10
L_poll_11:
    s_sub_u32 s54, s54, 1
    s_cbranch_scc1 L_end
    ds_read_b32 v19, v14
    s_waitcnt lgkmcnt(0)
    v_readfirstlane_b32 s65, v19
    s_cmp_ge_u32 s65, s66
    s_cbranch_scc0 L_poll_11
L_go_10:
    v_add_u32 v244, s67, v4
    v_add_u32 v245, s67, v5
    v_add_u32 v246, s67, v6
    v_add_u32 v247, s67, v7
    ds_read_b128 v[52:55], v244
    ds_read_b128 v[56:59], v244 offset:32
    ds_read_b128 v[60:63], v245
    ds_read_b128 v[64:67], v245 offset:32
    ds_read_b128 v[68:71], v246
    ds_read_b128 v[72:75], v246 offset:32
    ds_read_b128 v[76:79], v247
    ds_read_b128 v[80:83], v247 offset:32
    s_waitcnt lgkmcnt(7)
    v_mfma_f32_32x32x16_bf16 v[164:179], v[52:55], v[20:23], 0
    s_waitcnt lgkmcnt(6)
    v_mfma_f32_32x32x16_bf16 v[164:179], v[56:59], v[24:27], v[164:179]
    s_waitcnt lgkmcnt(5)
    v_mfma_f32_32x32x16_bf16 v[164:179], v[60:63], v[28:31], v[164:179]
    s_waitcnt lgkmcnt(4)
    v_mfma_f32_32x32x16_bf16 v[164:179], v[64:67], v[32:35], v[164:179]
    s_waitcnt lgkmcnt(3)
    v_mfma_f32_32x32x16_bf16 v[164:179], v[68:71], v[36:39], v[164:179]
    s_waitcnt lgkmcnt(2)
    v_mfma_f32_32x32x16_bf16 v[164:179], v[72:75], v[40:43], v[164:179]
    s_waitcnt lgkmcnt(1)
    v_mfma_f32_32x32x16_bf16 v[164:179], v[76:79], v[44:47], v[164:179]
    s_waitcnt lgkmcnt(0)
    v_mfma_f32_32x32x16_bf16 v[164:179], v[80:83], v[48:51], v[164:179]
    s_min_u32 s51, s68, s69
    v_mov_b32 v249, s51
    s_mov_b64 exec, 1
    ds_write_b32 v15, v249 offset:256
    s_mov_b64 exec, -1
    s_add_u32 s70, s70, 4
    s_add_u32 s66, s66, 32
    s_add_u32 s68, s68, 32
    s_add_u32 s67, s67, 33280
    s_cmp_ge_u32 s67, 74880
    s_cselect_b32 s50, 74880, 0
    s_sub_u32 s67, s67, s50
    s_nop 0
    v_max3_f32 v11, v11, v164, v165
    v_max3_f32 v11, v11, v166, v167
    v_max3_f32 v11, v11, v168, v169
    v_max3_f32 v11, v11, v170, v171
    v_max3_f32 v11, v11, v172, v173
    v_max3_f32 v11, v11, v174, v175
    v_max3_f32 v11, v11, v176, v177
    v_max3_f32 v11, v11, v178, v179
    v_fma_f32 v68, v164, s76, -v251
    v_fma_f32 v69, v165, s76, -v251
    v_fma_f32 v70, v166, s76, -v251
    v_fma_f32 v71, v167, s76, -v251
    v_fma_f32 v72, v168, s76, -v251
    v_fma_f32 v73, v169, s76, -v251
    v_fma_f32 v74, v170, s76, -v251
    v_fma_f32 v75, v171, s76, -v251
    v_fma_f32 v76, v172, s76, -v251
    v_fma_f32 v77, v173, s76, -v251
    v_fma_f32 v78, v174, s76, -v251
    v_fma_f32 v79, v175, s76, -v251
    v_fma_f32 v80, v176, s76, -v251
    v_fma_f32 v81, v177, s76, -v251
    v_fma_f32 v82, v178, s76, -v251
    v_fma_f32 v83, v179, s76, -v251
    v_exp_f32 v68, v68
    v_exp_f32 v69, v69
    v_exp_f32 v70, v70
    v_exp_f32 v71, v71
    v_exp_f32 v72, v72
    v_exp_f32 v73, v73
    v_exp_f32 v74, v74
    v_exp_f32 v75, v75
    v_exp_f32 v76, v76
    v_exp_f32 v77, v77
    v_exp_f32 v78, v78
    v_exp_f32 v79, v79
    v_exp_f32 v80, v80
    v_exp_f32 v81, v81
    v_exp_f32 v82, v82
    v_exp_f32 v83, v83
    v_add_f32 v12, v12, v68
    v_add_f32 v13, v13, v69
    v_cvt_pk_bf16_f32 v52, v68, v69
    v_add_f32 v12, v12, v70
    v_add_f32 v13, v13, v71
    v_cvt_pk_bf16_f32 v53, v70, v71
    v_add_f32 v12, v12, v72
    v_add_f32 v13, v13, v73
    v_cvt_pk_bf16_f32 v54, v72, v73
    v_add_f32 v12, v12, v74
    v_add_f32 v13, v13, v75
    v_cvt_pk_bf16_f32 v55, v74, v75
    v_add_f32 v12, v12, v76
    v_add_f32 v13, v13, v77
    v_cvt_pk_bf16_f32 v56, v76, v77
    v_add_f32 v12, v12, v78
    v_add_f32 v13, v13, v79
    v_cvt_pk_bf16_f32 v57, v78, v79
    v_add_f32 v12, v12, v80
    v_add_f32 v13, v13, v81
    v_cvt_pk_bf16_f32 v58, v80, v81
    v_add_f32 v12, v12, v82
    v_add_f32 v13, v13, v83
    v_cvt_pk_bf16_f32 v59, v82, v83
    ds_write_b128 v248, v[52:55]
    ds_write_b128 v248, v[56:59] offset:1024
    v_add_u32 v248, 8192, v248
    s_cmp_ge_u32 s70, s71
    s_cbranch_scc1 L_klast
    s_cmp_ge_u32 s65, s66
    s_cbranch_scc1 L_go_12
L_poll_13:
    s_sub_u32 s54, s54, 1
    s_cbranch_scc1 L_end
    ds_read_b32 v19, v14
    s_waitcnt lgkmcnt(0)
    v_readfirstlane_b32 s65, v19
    s_cmp_ge_u32 s65, s66
    s_cbranch_scc0 L_poll_13
L_go_12:
    v_add_u32 v244, s67, v4
    v_add_u32 v245, s67, v5
    v_add_u32 v246, s67, v6
    v_add_u32 v247, s67, v7
    ds_read_b128 v[52:55], v244
    ds_read_b128 v[56:59], v244 offset:32
    ds_read_b128 v[60:63], v245
    ds_read_b128 v[64:67], v245 offset:32
    ds_read_b128 v[68:71], v246
    ds_read_b128 v[72:75], v246 offset:32
    ds_read_b128 v[76:79], v247
    ds_read_b128 v[80:83], v247 offset:32
    s_waitcnt lgkmcnt(7)
    v_mfma_f32_32x32x16_bf16 v[180:195], v[52:55], v[20:23], 0
    s_waitcnt lgkmcnt(6)
    v_mfma_f32_32x32x16_bf16 v[180:195], v[56:59], v[24:27], v[180:195]
    s_waitcnt lgkmcnt(5)
    v_mfma_f32_32x32x16_bf16 v[180:195], v[60:63], v[28:31], v[180:195]
    s_waitcnt lgkmcnt(4)
    v_mfma_f32_32x32x16_bf16 v[180:195], v[64:67], v[32:35], v[180:195]
    s_waitcnt lgkmcnt(3)
    v_mfma_f32_32x32x16_bf16 v[180:195], v[68:71], v[36:39], v[180:195]
    s_waitcnt lgkmcnt(2)
    v_mfma_f32_32x32x16_bf16 v[180:195], v[72:75], v[40:43], v[180:195]
    s_waitcnt lgkmcnt(1)
    v_mfma_f32_32x32x16_bf16 v[180:195], v[76:79], v[44:47], v[180:195]
    s_waitcnt lgkmcnt(0)
    v_mfma_f32_32x32x16_bf16 v[180:195], v[80:83], v[48:51], v[180:195]
    s_min_u32 s51, s68, s69
    v_mov_b32 v249, s51
    s_mov_b64 exec, 1
    ds_write_b32 v15, v249 offset:256
    s_mov_b64 exec, -1
    s_add_u32 s70, s70, 4
    s_add_u32 s66, s66, 32
    s_add_u32 s68, s68, 32
    s_add_u32 s67, s67, 33280
    s_cmp_ge_u32 s67, 74880
    s_cselect_b32 s50, 74880, 0
    s_sub_u32 s67, s67, s50
    s_nop 0
    v_max3_f32 v11, v11, v180, v181
    v_max3_f32 v11, v11, v182, v183
    v_max3_f32 v11, v11, v184, v185
    v_max3_f32 v11, v11, v186, v187
    v_max3_f32 v11, v11, v188, v189
    v_max3_f32 v11, v11, v190, v191
    v_max3_f32 v11, v11, v192, v193
    v_max3_f32 v11, v11, v194, v195
    v_fma_f32 v68, v180, s76, -v251
    v_fma_f32 v69, v181, s76, -v251
    v_fma_f32 v70, v182, s76, -v251
    v_fma_f32 v71, v183, s76, -v251
    v_fma_f32 v72, v184, s76, -v251
    v_fma_f32 v73, v185, s76, -v251
    v_fma_f32 v74, v186, s76, -v251
    v_fma_f32 v75, v187, s76, -v251
    v_fma_f32 v76, v188, s76, -v251
    v_fma_f32 v77, v189, s76, -v251
    v_fma_f32 v78, v190, s76, -v251
    v_fma_f32 v79, v191, s76, -v251
    v_fma_f32 v80, v192, s76, -v251
    v_fma_f32 v81, v193, s76, -v251
    v_fma_f32 v82, v194, s76, -v251
    v_fma_f32 v83, v195, s76, -v251
    v_exp_f32 v68, v68
    v_exp_f32 v69, v69
    v_exp_f32 v70, v70
    v_exp_f32 v71, v71
    v_exp_f32 v72, v72
    v_exp_f32 v73, v73
    v_exp_f32 v74, v74
    v_exp_f32 v75, v75
    v_exp_f32 v76, v76
    v_exp_f32 v77, v77
    v_exp_f32 v78, v78
    v_exp_f32 v79, v79
    v_exp_f32 v80, v80
    v_exp_f32 v81, v81
    v_exp_f32 v82, v82
    v_exp_f32 v83, v83
    v_add_f32 v12, v12, v68
    v_add_f32 v13, v13, v69
    v_cvt_pk_bf16_f32 v52, v68, v69
    v_add_f32 v12, v12, v70
    v_add_f32 v13, v13, v71
    v_cvt_pk_bf16_f32 v53, v70, v71
    v_add_f32 v12, v12, v72
    v_add_f32 v13, v13, v73
    v_cvt_pk_bf16_f32 v54, v72, v73
    v_add_f32 v12, v12, v74
    v_add_f32 v13, v13, v75
    v_cvt_pk_bf16_f32 v55, v74, v75
    v_add_f32 v12, v12, v76
    v_add_f32 v13, v13, v77
    v_cvt_pk_bf16_f32 v56, v76, v77
    v_add_f32 v12, v12, v78
    v_add_f32 v13, v13, v79
    v_cvt_pk_bf16_f32 v57, v78, v79
    v_add_f32 v12, v12, v80
    v_add_f32 v13, v13, v81
    v_cvt_pk_bf16_f32 v58, v80, v81
    v_add_f32 v12, v12, v82
    v_add_f32 v13, v13, v83
    v_cvt_pk_bf16_f32 v59, v82, v83
    ds_write_b128 v248, v[52:55]
    ds_write_b128 v248, v[56:59] offset:1024
    v_add_u32 v248, 8192, v248
    s_cmp_ge_u32 s70, s71
    s_cbranch_scc1 L_klast
    s_cmp_ge_u32 s65, s66
    s_cbranch_scc1 L_go_14
L_poll_15:
    s_sub_u32 s54, s54, 1
    s_cbranch_scc1 L_end
    ds_read_b32 v19, v14
    s_waitcnt lgkmcnt(0)
    v_readfirstlane_b32 s65, v19
    s_cmp_ge_u32 s65, s66
    s_cbranch_scc0 L_poll_15
L_go_14:
    v_add_u32 v244, s67, v4
    v_add_u32 v245, s67, v5
    v_add_u32 v246, s67, v6
    v_add_u32 v247, s67, v7
    ds_read_b128 v[52:55], v244
    ds_read_b128 v[56:59], v244 offset:32
    ds_read_b128 v[60:63], v245
    ds_read_b128 v[64:67], v245 offset:32
    ds_read_b128 v[68:71], v246
    ds_read_b128 v[72:75], v246 offset:32
    ds_read_b128 v[76:79], v247
    ds_read_b128 v[80:83], v247 offset:32
    s_waitcnt lgkmcnt(7)
    v_mfma_f32_32x32x16_bf16 v[196:211], v[52:55], v[20:23], 0
    s_waitcnt lgkmcnt(6)
    v_mfma_f32_32x32x16_bf16 v[196:211], v[56:59], v[24:27], v[196:211]
    s_waitcnt lgkmcnt(5)
    v_mfma_f32_32x32x16_bf16 v[196:211], v[60:63], v[28:31], v[196:211]
    s_waitcnt lgkmcnt(4)
    v_mfma_f32_32x32x16_bf16 v[196:211], v[64:67], v[32:35], v[196:211]
    s_waitcnt lgkmcnt(3)
    v_mfma_f32_32x32x16_bf16 v[196:211], v[68:71], v[36:39], v[196:211]
    s_waitcnt lgkmcnt(2)
    v_mfma_f32_32x32x16_bf16 v[196:211], v[72:75], v[40:43], v[196:211]
    s_waitcnt lgkmcnt(1)
    v_mfma_f32_32x32x16_bf16 v[196:211], v[76:79], v[44:47], v[196:211]
    s_waitcnt lgkmcnt(0)
    v_mfma_f32_32x32x16_bf16 v[196:211], v[80:83], v[48:51], v[196:211]
    s_min_u32 s51, s68, s69
    v_mov_b32 v249, s51
    s_mov_b64 exec, 1
    ds_write_b32 v15, v249 offset:256
    s_mov_b64 exec, -1
    s_add_u32 s70, s70, 4
    s_add_u32 s66, s66, 32
    s_add_u32 s68, s68, 32
    s_add_u32 s67, s67, 33280
    s_cmp_ge_u32 s67, 74880
    s_cselect_b32 s50, 74880, 0
    s_sub_u32 s67, s67, s50
    s_nop 0
    v_max3_f32 v11, v11, v196, v197
    v_max3_f32 v11, v11, v198, v199
    v_max3_f32 v11, v11, v200, v201
    v_max3_f32 v11, v11, v202, v203
    v_max3_f32 v11, v11, v204, v205
    v_max3_f32 v11, v11, v206, v207
    v_max3_f32 v11, v11, v208, v209
    v_max3_f32 v11, v11, v210, v211
    v_fma_f32 v68, v196, s76, -v251
    v_fma_f32 v69, v197, s76, -v251
    v_fma_f32 v70, v198, s76, -v251
    v_fma_f32 v71, v199, s76, -v251
    v_fma_f32 v72, v200, s76, -v251
    v_fma_f32 v73, v201, s76, -v251
    v_fma_f32 v74, v202, s76, -v251
    v_fma_f32 v75, v203, s76, -v251
    v_fma_f32 v76, v204, s76, -v251
    v_fma_f32 v77, v205, s76, -v251
    v_fma_f32 v78, v206, s76, -v251
    v_fma_f32 v79, v207, s76, -v251
    v_fma_f32 v80, v208, s76, -v251
    v_fma_f32 v81, v209, s76, -v251
    v_fma_f32 v82, v210, s76, -v251
    v_fma_f32 v83, v211, s76, -v251
    v_exp_f32 v68, v68
    v_exp_f32 v69, v69
    v_exp_f32 v70, v70
    v_exp_f32 v71, v71
    v_exp_f32 v72, v72
    v_exp_f32 v73, v73
    v_exp_f32 v74, v74
    v_exp_f32 v75, v75
    v_exp_f32 v76, v76
    v_exp_f32 v77, v77
    v_exp_f32 v78, v78
    v_exp_f32 v79, v79
    v_exp_f32 v80, v80
    v_exp_f32 v81, v81
    v_exp_f32 v82, v82
    v_exp_f32 v83, v83
    v_add_f32 v12, v12, v68
    v_add_f32 v13, v13, v69
    v_cvt_pk_bf16_f32 v52, v68, v69
    v_add_f32 v12, v12, v70
    v_add_f32 v13, v13, v71
    v_cvt_pk_bf16_f32 v53, v70, v71
    v_add_f32 v12, v12, v72
    v_add_f32 v13, v13, v73
    v_cvt_pk_bf16_f32 v54, v72, v73
    v_add_f32 v12, v12, v74
    v_add_f32 v13, v13, v75
    v_cvt_pk_bf16_f32 v55, v74, v75
    v_add_f32 v12, v12, v76
    v_add_f32 v13, v13, v77
    v_cvt_pk_bf16_f32 v56, v76, v77
    v_add_f32 v12, v12, v78
    v_add_f32 v13, v13, v79
    v_cvt_pk_bf16_f32 v57, v78, v79
    v_add_f32 v12, v12, v80
    v_add_f32 v13, v13, v81
    v_cvt_pk_bf16_f32 v58, v80, v81
    v_add_f32 v12, v12, v82
    v_add_f32 v13, v13, v83
    v_cvt_pk_bf16_f32 v59, v82, v83
    ds_write_b128 v248, v[52:55]
    ds_write_b128 v248, v[56:59] offset:1024
    v_add_u32 v248, 8192, v248
    s_cmp_ge_u32 s70, s71
    s_cbranch_scc1 L_klast
    s_cmp_ge_u32 s65, s66
    s_cbranch_scc1 L_go_16
L_poll_17:
    s_sub_u32 s54, s54, 1
    s_cbranch_scc1 L_end
    ds_read_b32 v19, v14
    s_waitcnt lgkmcnt(0)
    v_readfirstlane_b32 s65, v19
    s_cmp_ge_u32 s65, s66
    s_cbranch_scc0 L_poll_17
L_go_16:
    v_add_u32 v244, s67, v4
    v_add_u32 v245, s67, v5
    v_add_u32 v246, s67, v6
    v_add_u32 v247, s67, v7
    ds_read_b128 v[52:55], v244
    ds_read_b128 v[56:59], v244 offset:32
    ds_read_b128 v[60:63], v245
    ds_read_b128 v[64:67], v245 offset:32
    ds_read_b128 v[68:71], v246
    ds_read_b128 v[72:75], v246 offset:32
    ds_read_b128 v[76:79], v247
    ds_read_b128 v[80:83], v247 offset:32
    s_waitcnt lgkmcnt(7)
    v_mfma_f32_32x32x16_bf16 v[212:227], v[52:55], v[20:23], 0
    s_waitcnt lgkmcnt(6)
    v_mfma_f32_32x32x16_bf16 v[212:227], v[56:59], v[24:27], v[212:227]
    s_waitcnt lgkmcnt(5)
    v_mfma_f32_32x32x16_bf16 v[212:227], v[60:63], v[28:31], v[212:227]
    s_waitcnt lgkmcnt(4)
    v_mfma_f32_32x32x16_bf16 v[212:227], v[64:67], v[32:35], v[212:227]
    s_waitcnt lgkmcnt(3)
    v_mfma_f32_32x32x16_bf16 v[212:227], v[68:71], v[36:39], v[212:227]
    s_waitcnt lgkmcnt(2)
    v_mfma_f32_32x32x16_bf16 v[212:227], v[72:75], v[40:43], v[212:227]
    s_waitcnt lgkmcnt(1)
    v_mfma_f32_32x32x16_bf16 v[212:227], v[76:79], v[44:47], v[212:227]
    s_waitcnt lgkmcnt(0)
    v_mfma_f32_32x32x16_bf16 v[212:227], v[80:83], v[48:51], v[212:227]
    s_min_u32 s51, s68, s69
    v_mov_b32 v249, s51
    s_mov_b64 exec, 1
    ds_write_b32 v15, v249 offset:256
    s_mov_b64 exec, -1
    s_add_u32 s70, s70, 4
    s_add_u32 s66, s66, 32
    s_add_u32 s68, s68, 32
    s_add_u32 s67, s67, 33280
    s_cmp_ge_u32 s67, 74880
    s_cselect_b32 s50, 74880, 0
    s_sub_u32 s67, s67, s50
    s_nop 0
    v_max3_f32 v11, v11, v212, v213
    v_max3_f32 v11, v11, v214, v215
    v_max3_f32 v11, v11, v216, v217
    v_max3_f32 v11, v11, v218, v219
    v_max3_f32 v11, v11, v220, v221
    v_max3_f32 v11, v11, v222, v223
    v_max3_f32 v11, v11, v224, v225
    v_max3_f32 v11, v11, v226, v227
    v_fma_f32 v68, v212, s76, -v251
    v_fma_f32 v69, v213, s76, -v251
    v_fma_f32 v70, v214, s76, -v251
    v_fma_f32 v71, v215, s76, -v251
    v_fma_f32 v72, v216, s76, -v251
    v_fma_f32 v73, v217, s76, -v251
    v_fma_f32 v74, v218, s76, -v251
    v_fma_f32 v75, v219, s76, -v251
    v_fma_f32 v76, v220, s76, -v251
    v_fma_f32 v77, v221, s76, -v251
    v_fma_f32 v78, v222, s76, -v251
    v_fma_f32 v79, v223, s76, -v251
    v_fma_f32 v80, v224, s76, -v251
    v_fma_f32 v81, v225, s76, -v251
    v_fma_f32 v82, v226, s76, -v251
    v_fma_f32 v83, v227, s76, -v251
    v_exp_f32 v68, v68
    v_exp_f32 v69, v69
    v_exp_f32 v70, v70
    v_exp_f32 v71, v71
    v_exp_f32 v72, v72
    v_exp_f32 v73, v73
    v_exp_f32 v74, v74
    v_exp_f32 v75, v75
    v_exp_f32 v76, v76
    v_exp_f32 v77, v77
    v_exp_f32 v78, v78
    v_exp_f32 v79, v79
    v_exp_f32 v80, v80
    v_exp_f32 v81, v81
    v_exp_f32 v82, v82
    v_exp_f32 v83, v83
    v_add_f32 v12, v12, v68
    v_add_f32 v13, v13, v69
    v_cvt_pk_bf16_f32 v52, v68, v69
    v_add_f32 v12, v12, v70
    v_add_f32 v13, v13, v71
    v_cvt_pk_bf16_f32 v53, v70, v71
    v_add_f32 v12, v12, v72
    v_add_f32 v13, v13, v73
    v_cvt_pk_bf16_f32 v54, v72, v73
    v_add_f32 v12, v12, v74
    v_add_f32 v13, v13, v75
    v_cvt_pk_bf16_f32 v55, v74, v75
    v_add_f32 v12, v12, v76
    v_add_f32 v13, v13, v77
    v_cvt_pk_bf16_f32 v56, v76, v77
    v_add_f32 v12, v12, v78
    v_add_f32 v13, v13, v79
    v_cvt_pk_bf16_f32 v57, v78, v79
    v_add_f32 v12, v12, v80
    v_add_f32 v13, v13, v81
    v_cvt_pk_bf16_f32 v58, v80, v81
    v_add_f32 v12, v12, v82
    v_add_f32 v13, v13, v83
    v_cvt_pk_bf16_f32 v59, v82, v83
    ds_write_b128 v248, v[52:55]
    ds_write_b128 v248, v[56:59] offset:1024
    v_add_u32 v248, 8192, v248
L_klast:
    s_cmp_eq_u32 s70, s71
    s_cbranch_scc0 L_kdone
    s_add_u32 s66, s72, s48
    s_cmp_ge_u32 s65, s66
    s_cbranch_scc1 L_go_18
L_poll_19:
    s_sub_u32 s54, s54, 1
    s_cbranch_scc1 L_end
    ds_read_b32 v19, v14
    s_waitcnt lgkmcnt(0)
    v_readfirstlane_b32 s65, v19
    s_cmp_ge_u32 s65, s66
    s_cbranch_scc0 L_poll_19
L_go_18:
    v_add_u32 v244, s67, v4
    v_add_u32 v245, s67, v5
    v_add_u32 v246, s67, v6
    v_add_u32 v247, s67, v7
    ds_read_b128 v[52:55], v244
    ds_read_b128 v[56:59], v244 offset:32
    ds_read_b128 v[60:63], v245
    ds_read_b128 v[64:67], v245 offset:32
    ds_read_b128 v[68:71], v246
    ds_read_b128 v[72:75], v246 offset:32
    ds_read_b128 v[76:79], v247
    ds_read_b128 v[80:83], v247 offset:32
    s_waitcnt lgkmcnt(7)
    v_mfma_f32_32x32x16_bf16 v[228:243], v[52:55], v[20:23], 0
    s_waitcnt lgkmcnt(6)
    v_mfma_f32_32x32x16_bf16 v[228:243], v[56:59], v[24:27], v[228:243]
    s_waitcnt lgkmcnt(5)
    v_mfma_f32_32x32x16_bf16 v[228:243], v[60:63], v[28:31], v[228:243]
    s_waitcnt lgkmcnt(4)
    v_mfma_f32_32x32x16_bf16 v[228:243], v[64:67], v[32:35], v[228:243]
    s_waitcnt lgkmcnt(3)
    v_mfma_f32_32x32x16_bf16 v[228:243], v[68:71], v[36:39], v[228:243]
    s_waitcnt lgkmcnt(2)
    v_mfma_f32_32x32x16_bf16 v[228:243], v[72:75], v[40:43], v[228:243]
    s_waitcnt lgkmcnt(1)
    v_mfma_f32_32x32x16_bf16 v[228:243], v[76:79], v[44:47], v[228:243]
    s_waitcnt lgkmcnt(0)
    v_mfma_f32_32x32x16_bf16 v[228:243], v[80:83], v[48:51], v[228:243]
    s_min_u32 s51, s68, s69
    v_mov_b32 v249, s51
    s_mov_b64 exec, 1
    ds_write_b32 v15, v249 offset:256
    s_mov_b64 exec, -1
    s_lshl_b32 s50, s70, 5
    s_sub_u32 s50, s77, s50
    v_lshrrev_b32 v10, 5, v0
    v_lshlrev_b32 v10, 2, v10
    v_sub_u32 v10, s50, v10
    s_nop 2
    v_cmp_gt_i32 s[84:85], v10, 0
    v_cmp_gt_i32 s[86:87], v10, 1
    v_cmp_gt_i32 s[88:89], v10, 2
    v_cmp_gt_i32 s[90:91], v10, 3
    v_cndmask_b32 v228, v18, v228, s[84:85]
    v_cndmask_b32 v229, v18, v229, s[86:87]
    v_cndmask_b32 v230, v18, v230, s[88:89]
    v_cndmask_b32 v231, v18, v231, s[90:91]
    v_cmp_gt_i32 s[84:85], v10, 8
    v_cmp_gt_i32 s[86:87], v10, 9
    v_cmp_gt_i32 s[88:89], v10, 10
    v_cmp_gt_i32 s[90:91], v10, 11
    v_cndmask_b32 v232, v18, v232, s[84:85]
    v_cndmask_b32 v233, v18, v233, s[86:87]
    v_cndmask_b32 v234, v18, v234, s[88:89]
    v_cndmask_b32 v235, v18, v235, s[90:91]
    v_cmp_gt_i32 s[84:85], v10, 16
    v_cmp_gt_i32 s[86:87], v10, 17
    v_cmp_gt_i32 s[88:89], v10, 18
    v_cmp_gt_i32 s[90:91], v10, 19
    v_cndmask_b32 v236, v18, v236, s[84:85]
    v_cndmask_b32 v237, v18, v237, s[86:87]
    v_cndmask_b32 v238, v18, v238, s[88:89]
    v_cndmask_b32 v239, v18, v239, s[90:91]
    v_cmp_gt_i32 s[84:85], v10, 24
    v_cmp_gt_i32 s[86:87], v10, 25
    v_cmp_gt_i32 s[88:89], v10, 26
    v_cmp_gt_i32 s[90:91], v10, 27
    v_cndmask_b32 v240, v18, v240, s[84:85]
    v_cndmask_b32 v241, v18, v241, s[86:87]
    v_cndmask_b32 v242, v18, v242, s[88:89]
    v_cndmask_b32 v243, v18, v243, s[90:91]
    v_max3_f32 v11, v11, v228, v229
    v_max3_f32 v11, v11, v230, v231
    v_max3_f32 v11, v11, v232, v233
    v_max3_f32 v11, v11, v234, v235
    v_max3_f32 v11, v11, v236, v237
    v_max3_f32 v11, v11, v238, v239
    v_max3_f32 v11, v11, v240, v241
    v_max3_f32 v11, v11, v242, v243
    s_cmp_eq_u32 s60, 0
    s_cbranch_scc1 L_kdone
    v_fma_f32 v68, v228, s76, -v251
    v_fma_f32 v69, v229, s76, -v251
    v_fma_f32 v70, v230, s76, -v251
    v_fma_f32 v71, v231, s76, -v251
    v_fma_f32 v72, v232, s76, -v251
    v_fma_f32 v73, v233, s76, -v251
    v_fma_f32 v74, v234, s76, -v251
    v_fma_f32 v75, v235, s76, -v251
    v_fma_f32 v76, v236, s76, -v251
    v_fma_f32 v77, v237, s76, -v251
    v_fma_f32 v78, v238, s76, -v251
    v_fma_f32 v79, v239, s76, -v251
    v_fma_f32 v80, v240, s76, -v251
    v_fma_f32 v81, v241, s76, -v251
    v_fma_f32 v82, v242, s76, -v251
    v_fma_f32 v83, v243, s76, -v251
    v_exp_f32 v68, v68
    v_exp_f32 v69, v69
    v_exp_f32 v70, v70
    v_exp_f32 v71, v71
    v_exp_f32 v72, v72
    v_exp_f32 v73, v73
    v_exp_f32 v74, v74
    v_exp_f32 v75, v75
    v_exp_f32 v76, v76
    v_exp_f32 v77, v77
    v_exp_f32 v78, v78
    v_exp_f32 v79, v79
    v_exp_f32 v80, v80
    v_exp_f32 v81, v81
    v_exp_f32 v82, v82
    v_exp_f32 v83, v83
    v_add_f32 v12, v12, v68
    v_add_f32 v13, v13, v69
    v_cvt_pk_bf16_f32 v52, v68, v69
    v_add_f32 v12, v12, v70
    v_add_f32 v13, v13, v71
    v_cvt_pk_bf16_f32 v53, v70, v71
    v_add_f32 v12, v12, v72
    v_add_f32 v13, v13, v73
    v_cvt_pk_bf16_f32 v54, v72, v73
    v_add_f32 v12, v12, v74
    v_add_f32 v13, v13, v75
    v_cvt_pk_bf16_f32 v55, v74, v75
    v_add_f32 v12, v12, v76
    v_add_f32 v13, v13, v77
    v_cvt_pk_bf16_f32 v56, v76, v77
    v_add_f32 v12, v12, v78
    v_add_f32 v13, v13, v79
    v_cvt_pk_bf16_f32 v57, v78, v79
    v_add_f32 v12, v12, v80
    v_add_f32 v13, v13, v81
    v_cvt_pk_bf16_f32 v58, v80, v81
    v_add_f32 v12, v12, v82
    v_add_f32 v13, v13, v83
    v_cvt_pk_bf16_f32 v59, v82, v83
    ds_write_b128 v248, v[52:55]
    ds_write_b128 v248, v[56:59] offset:1024
    v_add_u32 v248, 8192, v248
L_kdone:
    v_mov_b32 v249, s69
    s_mov_b64 exec, 1
    ds_write_b32 v15, v249 offset:256
    s_mov_b64 exec, -1
    v_add_f32 v12, v12, v13
    v_mov_b32 v19, v11
    s_nop 1
    v_permlane32_swap_b32 v11, v19
    v_max_f32 v11, v11, v19
    v_mov_b32 v19, v12
    s_nop 1
    v_permlane32_swap_b32 v12, v19
    v_add_f32 v12, v12, v19
    s_add_u32 s75, s75, 1
    v_mov_b32 v249, s75
    s_mov_b32 exec_hi, 0
    ds_write_b32 v16, v11 offset:832
    ds_write_b32 v16, v12 offset:1344
    s_mov_b64 exec, 1
    ds_write_b32 v15, v249 offset:272
    s_mov_b64 exec, -1
L_sync_20:
    s_sub_u32 s54, s54, 1
    s_cbranch_scc1 L_end
    ds_read_b128 v[60:63], v14 offset:272
    ds_read_b128 v[52:55], v17 offset:832
    ds_read_b128 v[56:59], v17 offset:1344
    s_waitcnt lgkmcnt(0)
    v_min3_u32 v60, v60, v61, v62
    v_min_u32 v60, v60, v63
    s_nop 0
    v_readfirstlane_b32 s50, v60
    s_cmp_ge_u32 s50, s75
    s_cbranch_scc0 L_sync_20
    v_max3_f32 v11, v52, v53, v54
    v_max_f32 v11, v11, v55
    v_add_f32 v12, v56, v57
    v_add_f32 v13, v58, v59
    v_fma_f32 v19, v11, s76, -v251
    v_add_f32 v12, v12, v13
    v_cmp_nge_f32 vcc, 0x41800000, v19
    s_cmp_eq_u32 s60, 0
    s_cbranch_scc1 L_redo
    s_cmp_lg_u64 vcc, 0
    s_cbranch_scc1 L_redo
L_pready:
    ds_read_b32 v19, v14 offset:304
    v_log_f32 v253, v12
    v_rcp_f32 v252, v12
    s_waitcnt lgkmcnt(0)
    v_readfirstlane_b32 s99, v19
    v_add_f32 v253, v253, v251
    s_add_u32 s50, s47, s40
    s_cmp_lt_u32 s50, s42
    s_cselect_b32 s70, s64, 1
    s_cmp_eq_u32 s70, 0
    s_cbranch_scc0 L_noq2
    s_add_u32 s52, s43, 1
    s_lshl_b32 s50, s52, 16
    s_lshl_b32 s51, s37, 13
    s_add_u32 s50, s50, s51
    s_mov_b32 m0, 74880
    s_nop 0
    buffer_load_dwordx4 v250, s[20:23], s50 offen lds
    s_add_u32 m0, m0, 1040
    s_add_u32 s50, s50, 1024
    buffer_load_dwordx4 v250, s[20:23], s50 offen lds
    s_add_u32 m0, m0, 1040
    s_add_u32 s50, s50, 1024
    buffer_load_dwordx4 v250, s[20:23], s50 offen lds
    s_add_u32 m0, m0, 1040
    s_add_u32 s50, s50, 1024
    buffer_load_dwordx4 v250, s[20:23], s50 offen lds
    s_add_u32 m0, m0, 1040
    s_add_u32 s50, s50, 1024
    buffer_load_dwordx4 v250, s[20:23], s50 offen lds
    s_add_u32 m0, m0, 1040
    s_add_u32 s50, s50, 1024
    buffer_load_dwordx4 v250, s[20:23], s50 offen lds
    s_add_u32 m0, m0, 1040
    s_add_u32 s50, s50, 1024
    buffer_load_dwordx4 v250, s[20:23], s50 offen lds
    s_add_u32 m0, m0, 1040
    s_add_u32 s50, s50, 1024
    buffer_load_dwordx4 v250, s[20:23], s50 offen lds
L_noq2:
    s_sub_u32 s52, s44, s45
    v_mul_u32_u24 v244, s39, v0
    v_lshrrev_b32 v19, 5, v244
    v_cmp_gt_u32 vcc, s44, v19
    v_add_u32 v244, s39, v244
    v_lshrrev_b32 v244, 5, v244
    v_cmp_lt_u32 s[84:85], s52, v244
    s_and_b32 s50, vcc_lo, s84
    s_ff1_i32_b32 s79, s50
    s_bcnt1_i32_b32 s82, s50
    s_lshl_b32 s33, s43, 3
    s_add_u32 s33, s33, s37
    s_add_u32 s33, s33, 256
    s_sub_u32 s63, s38, s79
    s_mov_b32 s93, -1
    s_mov_b32 s61, 0
    s_cmp_eq_u32 s82, 1
    s_cbranch_scc1 L_own_done
    s_cmp_eq_u32 s63, 0
    s_cselect_b32 s50, s33, s2
    s_lshl_b32 s62, s50, 2
    s_add_u32 s62, s62, s64
    s_mul_i32 s62, s62, 2560
    s_sub_u32 s51, s82, 1
    s_mov_b32 s52, s64
    s_cmp_ge_u32 s52, s51
    s_cselect_b32 s50, s51, 0
    s_sub_u32 s52, s52, s50
    s_cmp_ge_u32 s52, s51
    s_cselect_b32 s50, s51, 0
    s_sub_u32 s52, s52, s50
    s_cmp_ge_u32 s52, s51
    s_cselect_b32 s50, s51, 0
    s_sub_u32 s52, s52, s50
    s_cmp_eq_u32 s52, s63
    s_cselect_b32 s61, 1, 0
    s_add_u32 s52, s52, s79
    s_lshl_b32 s52, s52, 3
    s_add_u32 s52, s52, s37
    s_lshl_b32 s52, s52, 6
    s_add_u32 s52, s52, 3276800
    v_mov_b32 v19, 0
    buffer_load_dwordx2 v[242:243], v19, s[24:27], s52 offen sc1
    s_mov_b32 s83, 0
    s_mov_b32 s98, 0
    s_cmp_eq_u32 s83, s63
    s_addc_u32 s83, s83, 0
    s_add_u32 s50, s79, s83
    s_lshl_b32 s50, s50, 3
    s_add_u32 s50, s50, s37
    s_cmp_eq_u32 s83, 0
    s_cselect_b32 s50, s33, s50
    s_lshl_b32 s55, s50, 2
    s_add_u32 s55, s55, s64
    s_mul_i32 s55, s55, 2560
    s_cmp_lt_u32 s83, s82
    s_cselect_b32 s50, 1, 0
    s_or_b32 s98, s98, s50
    s_add_u32 s83, s83, 1
    s_cmp_eq_u32 s83, s63
    s_addc_u32 s83, s83, 0
    s_add_u32 s50, s79, s83
    s_lshl_b32 s50, s50, 3
    s_add_u32 s50, s50, s37
    s_cmp_eq_u32 s83, 0
    s_cselect_b32 s50, s33, s50
    s_lshl_b32 s56, s50, 2
    s_add_u32 s56, s56, s64
    s_mul_i32 s56, s56, 2560
    s_cmp_lt_u32 s83, s82
    s_cselect_b32 s50, 2, 0
    s_or_b32 s98, s98, s50
    s_add_u32 s83, s83, 1
    s_cmp_eq_u32 s83, s63
    s_addc_u32 s83, s83, 0
    s_add_u32 s50, s79, s83
    s_lshl_b32 s50, s50, 3
    s_add_u32 s50, s50, s37
    s_cmp_eq_u32 s83, 0
    s_cselect_b32 s50, s33, s50
    s_lshl_b32 s57, s50, 2
    s_add_u32 s57, s57, s64
    s_mul_i32 s57, s57, 2560
    s_cmp_lt_u32 s83, s82
    s_cselect_b32 s50, 4, 0
    s_or_b32 s98, s98, s50
    s_add_u32 s83, s83, 1
    s_cmp_eq_u32 s83, s63
    s_addc_u32 s83, s83, 0
    s_add_u32 s50, s79, s83
    s_lshl_b32 s50, s50, 3
    s_add_u32 s50, s50, s37
    s_cmp_eq_u32 s83, 0
    s_cselect_b32 s50, s33, s50
    s_lshl_b32 s58, s50, 2
    s_add_u32 s58, s58, s64
    s_mul_i32 s58, s58, 2560
    s_cmp_lt_u32 s83, s82
    s_cselect_b32 s50, 8, 0
    s_or_b32 s98, s98, s50
    s_add_u32 s83, s83, 1
    s_cmp_eq_u32 s83, s63
    s_addc_u32 s83, s83, 0
    s_add_u32 s50, s79, s83
    s_lshl_b32 s50, s50, 3
    s_add_u32 s50, s50, s37
    s_cmp_eq_u32 s83, 0
    s_cselect_b32 s50, s33, s50
    s_lshl_b32 s59, s50, 2
    s_add_u32 s59, s59, s64
    s_mul_i32 s59, s59, 2560
    s_cmp_lt_u32 s83, s82
    s_cselect_b32 s50, 16, 0
    s_or_b32 s98, s98, s50
    s_add_u32 s83, s83, 1
    s_mov_b32 s92, s98
    v_mov_b32 v241, 0
    v_mov_b32 v108, v18
    v_mov_b32 v109, v18
    v_mov_b32 v230, 0
    v_mov_b32 v231, v18
    v_mov_b64 v[100:101], 0
    v_mov_b64 v[102:103], 0
    v_mov_b64 v[104:105], 0
    v_mov_b64 v[106:107], 0
    v_mov_b32 v118, v18
    v_mov_b32 v119, v18
    v_mov_b32 v232, 0
    v_mov_b32 v233, v18
    v_mov_b64 v[110:111], 0
    v_mov_b64 v[112:113], 0
    v_mov_b64 v[114:115], 0
    v_mov_b64 v[116:117], 0
    v_mov_b32 v128, v18
    v_mov_b32 v129, v18
    v_mov_b32 v234, 0
    v_mov_b32 v235, v18
    v_mov_b64 v[120:121], 0
    v_mov_b64 v[122:123], 0
    v_mov_b64 v[124:125], 0
    v_mov_b64 v[126:127], 0
    v_mov_b32 v138, v18
    v_mov_b32 v139, v18
    v_mov_b32 v236, 0
    v_mov_b32 v237, v18
    v_mov_b64 v[130:131], 0
    v_mov_b64 v[132:133], 0
    v_mov_b64 v[134:135], 0
    v_mov_b64 v[136:137], 0
    v_mov_b32 v148, v18
    v_mov_b32 v149, v18
    v_mov_b32 v238, 0
    v_mov_b32 v239, v18
    v_mov_b64 v[140:141], 0
    v_mov_b64 v[142:143], 0
    v_mov_b64 v[144:145], 0
    v_mov_b64 v[146:147], 0
    s_cmp_gt_u32 s49, 7
    s_cselect_b32 s93, 4, 0
L_own_done:
    v_mov_b64 v[84:85], 0
    v_mov_b64 v[86:87], 0
    v_mov_b64 v[88:89], 0
    v_mov_b64 v[90:91], 0
    v_mov_b64 v[92:93], 0
    v_mov_b64 v[94:95], 0
    v_mov_b64 v[96:97], 0
    v_mov_b64 v[98:99], 0
    s_mov_b32 s80, s49
    s_add_u32 s66, s72, s48
    s_add_u32 s78, s66, s48
    s_mov_b32 s72, s78
    s_mov_b32 s68, s69
    s_mul_i32 s51, s49, 57
    s_lshr_b32 s51, s51, 9
    s_mul_i32 s51, s51, 9
    s_sub_u32 s51, s49, s51
    s_mul_i32 s51, s51, 8320
    s_add_u32 s81, s74, s51
    s_cmp_ge_u32 s81, 74880
    s_cselect_b32 s50, 74880, 0
    s_sub_u32 s81, s81, s50
    s_add_u32 s74, s81, s51
    s_cmp_ge_u32 s74, 74880
    s_cselect_b32 s50, 74880, 0
    s_sub_u32 s74, s74, s50
    s_lshl_b32 s51, s49, 4
    s_add_u32 s73, s73, s51
    v_mov_b32 v248, v9
    v_lshlrev_b32 v245, 4, v0
    v_lshlrev_b32 v246, 3, v0
    v_and_b32 v10, 31, v0
    v_lshlrev_b32 v10, 8, v10
    v_lshrrev_b32 v13, 5, v0
    v_lshl_add_u32 v10, v13, 4, v10
    s_lshl_b32 s67, s43, 16
    s_lshl_b32 s51, s37, 13
    s_add_u32 s67, s67, s51
    s_lshl_b32 s51, s64, 6
    s_add_u32 s67, s67, s51
    s_add_u32 s89, s66, 4
    s_min_u32 s89, s89, s78
    s_add_u32 s88, s66, 8
    s_min_u32 s88, s88, s78
L_pv:
    ds_read_b128 v[52:55], v248
    ds_read_b128 v[56:59], v248 offset:1024
    v_add_u32 v244, s81, v8
    s_cmp_ge_u32 s65, s89
    s_cbranch_scc1 L_go_21
L_poll_22:
    s_sub_u32 s54, s54, 1
    s_cbranch_scc1 L_end
    ds_read_b32 v19, v14
    s_waitcnt lgkmcnt(0)
    v_readfirstlane_b32 s65, v19
    s_cmp_ge_u32 s65, s89
    s_cbranch_scc0 L_poll_22
L_go_21:
    ds_read_b64_tr_b16 v[60:61], v244 offset:0
    ds_read_b64_tr_b16 v[62:63], v244 offset:2080
    s_cmp_ge_u32 s65, s88
    s_cbranch_scc1 L_pv2
    s_waitcnt lgkmcnt(0)
    v_mfma_f32_32x32x16_bf16 v[84:99], v[60:63], v[52:55], v[84:99]
L_pvp:
    s_sub_u32 s54, s54, 1
    s_cbranch_scc1 L_end
    ds_read_b32 v19, v14
    s_waitcnt lgkmcnt(0)
    v_readfirstlane_b32 s65, v19
    s_cmp_ge_u32 s65, s88
    s_cbranch_scc0 L_pvp
    ds_read_b64_tr_b16 v[64:65], v244 offset:4160
    ds_read_b64_tr_b16 v[66:67], v244 offset:6240
    s_add_u32 s81, s81, 8320
    s_cmp_ge_u32 s81, 74880
    s_cselect_b32 s81, 0, s81
    s_add_u32 s68, s68, 8
    v_add_u32 v248, 2048, v248
    v_mov_b32 v249, s68
    s_sub_u32 s80, s80, 1
    s_add_u32 s89, s88, 4
    s_min_u32 s89, s89, s78
    s_add_u32 s88, s88, 8
    s_min_u32 s88, s88, s78
    s_waitcnt lgkmcnt(0)
    s_branch L_pv3
L_pv2:
    ds_read_b64_tr_b16 v[64:65], v244 offset:4160
    ds_read_b64_tr_b16 v[66:67], v244 offset:6240
    s_add_u32 s81, s81, 8320
    s_cmp_ge_u32 s81, 74880
    s_cselect_b32 s81, 0, s81
    s_add_u32 s68, s68, 8
    v_add_u32 v248, 2048, v248
    v_mov_b32 v249, s68
    s_sub_u32 s80, s80, 1
    s_add_u32 s89, s88, 4
    s_min_u32 s89, s89, s78
    s_add_u32 s88, s88, 8
    s_min_u32 s88, s88, s78
    s_waitcnt lgkmcnt(2)
    v_mfma_f32_32x32x16_bf16 v[84:99], v[60:63], v[52:55], v[84:99]
    s_waitcnt lgkmcnt(0)
L_pv3:
    v_mfma_f32_32x32x16_bf16 v[84:99], v[64:67], v[56:59], v[84:99]
    s_mov_b64 exec, 1
    ds_write_b32 v15, v249 offset:256
    s_mov_b64 exec, -1
    s_cmp_le_i32 s80, s93
    s_cbranch_scc1 L_hook
L_pv4:
    s_cmp_lg_u32 s80, 0
    s_cbranch_scc1 L_pv
    s_cmp_eq_u32 s70, 0
    s_cbranch_scc1 L_qflag
L_qflag_done:
    s_cmp_eq_u32 s61, 1
    s_cbranch_scc1 L_owner
    s_cmp_eq_u32 s82, 1
    v_pk_mul_f32 v[84:85], v[84:85], v[252:253] op_sel_hi:[1,0]
    v_pk_mul_f32 v[86:87], v[86:87], v[252:253] op_sel_hi:[1,0]
    v_pk_mul_f32 v[88:89], v[88:89], v[252:253] op_sel_hi:[1,0]
    v_pk_mul_f32 v[90:91], v[90:91], v[252:253] op_sel_hi:[1,0]
    v_pk_mul_f32 v[92:93], v[92:93], v[252:253] op_sel_hi:[1,0]
    v_pk_mul_f32 v[94:95], v[94:95], v[252:253] op_sel_hi:[1,0]
    v_pk_mul_f32 v[96:97], v[96:97], v[252:253] op_sel_hi:[1,0]
    v_pk_mul_f32 v[98:99], v[98:99], v[252:253] op_sel_hi:[1,0]
    s_cbranch_scc1 L_final
    s_cmp_eq_u32 s91, 0
    s_cbranch_scc1 L_far
    v_cvt_pk_bf16_f32 v52, v84, v85
    v_cvt_pk_bf16_f32 v53, v86, v87
    v_cvt_pk_bf16_f32 v54, v88, v89
    v_cvt_pk_bf16_f32 v55, v90, v91
    buffer_store_dwordx4 v[52:55], v245, s[24:27], s62 offen
    v_cvt_pk_bf16_f32 v56, v92, v93
    v_cvt_pk_bf16_f32 v57, v94, v95
    v_cvt_pk_bf16_f32 v58, v96, v97
    v_cvt_pk_bf16_f32 v59, v98, v99
    buffer_store_dwordx4 v[56:59], v245, s[24:27], s62 offen offset:1024
    v_add3_u32 v61, v253, s99, v52
    v_add3_u32 v62, v53, v54, v55
    v_add3_u32 v61, v61, v56, v57
    v_add3_u32 v62, v62, v58, v59
    v_mov_b32 v60, v253
    v_add_u32 v61, v61, v62
    buffer_store_dwordx2 v[60:61], v246, s[24:27], s62 offen offset:2048
    s_branch L_segnext
L_far:
    v_cvt_pk_bf16_f32 v52, v84, v85
    v_cvt_pk_bf16_f32 v53, v86, v87
    v_cvt_pk_bf16_f32 v54, v88, v89
    v_cvt_pk_bf16_f32 v55, v90, v91
    buffer_store_dwordx4 v[52:55], v245, s[24:27], s62 offen sc1
    v_cvt_pk_bf16_f32 v56, v92, v93
    v_cvt_pk_bf16_f32 v57, v94, v95
    v_cvt_pk_bf16_f32 v58, v96, v97
    v_cvt_pk_bf16_f32 v59, v98, v99
    buffer_store_dwordx4 v[56:59], v245, s[24:27], s62 offen offset:1024 sc1
    v_add3_u32 v61, v253, s99, v52
    v_add3_u32 v62, v53, v54, v55
    v_add3_u32 v61, v61, v56, v57
    v_add3_u32 v62, v62, v58, v59
    v_mov_b32 v60, v253
    v_add_u32 v61, v61, v62
    buffer_store_dwordx2 v[60:61], v246, s[24:27], s62 offen offset:2048 sc1
    s_branch L_segnext
L_owner:
    s_waitcnt vmcnt(0)
    s_bitcmp1_b32 s98, 0
    s_cbranch_scc0 L_nold_23
    buffer_load_dwordx4 v[20:23], v245, s[24:27], s55 offen sc1
    buffer_load_dwordx4 v[24:27], v245, s[24:27], s55 offen offset:1024 sc1
    buffer_load_dwordx2 v[28:29], v246, s[24:27], s55 offen offset:2048 sc1
L_nold_23:
    s_bitcmp1_b32 s98, 1
    s_cbranch_scc0 L_nold_24
    buffer_load_dwordx4 v[30:33], v245, s[24:27], s56 offen sc1
    buffer_load_dwordx4 v[34:37], v245, s[24:27], s56 offen offset:1024 sc1
    buffer_load_dwordx2 v[38:39], v246, s[24:27], s56 offen offset:2048 sc1
L_nold_24:
    s_bitcmp1_b32 s98, 2
    s_cbranch_scc0 L_nold_25
    buffer_load_dwordx4 v[40:43], v245, s[24:27], s57 offen sc1
    buffer_load_dwordx4 v[44:47], v245, s[24:27], s57 offen offset:1024 sc1
    buffer_load_dwordx2 v[48:49], v246, s[24:27], s57 offen offset:2048 sc1
L_nold_25:
    s_bitcmp1_b32 s98, 3
    s_cbranch_scc0 L_nold_26
    buffer_load_dwordx4 v[50:53], v245, s[24:27], s58 offen sc1
    buffer_load_dwordx4 v[54:57], v245, s[24:27], s58 offen offset:1024 sc1
    buffer_load_dwordx2 v[58:59], v246, s[24:27], s58 offen offset:2048 sc1
L_nold_26:
    s_bitcmp1_b32 s98, 4
    s_cbranch_scc0 L_nold_27
    buffer_load_dwordx4 v[60:63], v245, s[24:27], s59 offen sc1
    buffer_load_dwordx4 v[64:67], v245, s[24:27], s59 offen offset:1024 sc1
    buffer_load_dwordx2 v[68:69], v246, s[24:27], s59 offen offset:2048 sc1
L_nold_27:
    v_pk_mul_f32 v[84:85], v[84:85], v[252:253] op_sel_hi:[1,0]
    v_pk_mul_f32 v[86:87], v[86:87], v[252:253] op_sel_hi:[1,0]
    v_pk_mul_f32 v[88:89], v[88:89], v[252:253] op_sel_hi:[1,0]
    v_pk_mul_f32 v[90:91], v[90:91], v[252:253] op_sel_hi:[1,0]
    v_pk_mul_f32 v[92:93], v[92:93], v[252:253] op_sel_hi:[1,0]
    v_pk_mul_f32 v[94:95], v[94:95], v[252:253] op_sel_hi:[1,0]
    v_pk_mul_f32 v[96:97], v[96:97], v[252:253] op_sel_hi:[1,0]
    v_pk_mul_f32 v[98:99], v[98:99], v[252:253] op_sel_hi:[1,0]
    s_bitcmp1_b32 s98, 0
    s_cbranch_scc0 L_nock_28
    v_add3_u32 v19, v108, s99, v100
    v_add3_u32 v13, v101, v102, v103
    v_add3_u32 v19, v19, v104, v105
    v_add3_u32 v13, v13, v106, v107
    v_add_u32 v19, v19, v13
    v_cmp_ne_u32 vcc, v19, v109
    v_sub_f32 v19, v108, v253
    s_cmp_lg_u64 vcc, 0
    s_cbranch_scc1 L_nock_28
    v_exp_f32 v230, v19
    v_max_f32 v241, v241, v19
    v_mov_b32 v231, v108
    s_bitset0_b32 s98, 0
    v_lshlrev_b32 v150, 16, v100
    v_and_b32 v151, 0xffff0000, v100
    v_lshlrev_b32 v152, 16, v101
    v_and_b32 v153, 0xffff0000, v101
    v_lshlrev_b32 v154, 16, v102
    v_and_b32 v155, 0xffff0000, v102
    v_lshlrev_b32 v156, 16, v103
    v_and_b32 v157, 0xffff0000, v103
    v_lshlrev_b32 v158, 16, v104
    v_and_b32 v159, 0xffff0000, v104
    v_lshlrev_b32 v160, 16, v105
    v_and_b32 v161, 0xffff0000, v105
    v_lshlrev_b32 v162, 16, v106
    v_and_b32 v163, 0xffff0000, v106
    v_lshlrev_b32 v164, 16, v107
    v_and_b32 v165, 0xffff0000, v107
L_nock_28:
    s_bitcmp1_b32 s98, 1
    s_cbranch_scc0 L_nock_29
    v_add3_u32 v19, v118, s99, v110
    v_add3_u32 v13, v111, v112, v113
    v_add3_u32 v19, v19, v114, v115
    v_add3_u32 v13, v13, v116, v117
    v_add_u32 v19, v19, v13
    v_cmp_ne_u32 vcc, v19, v119
    v_sub_f32 v19, v118, v253
    s_cmp_lg_u64 vcc, 0
    s_cbranch_scc1 L_nock_29
    v_exp_f32 v232, v19
    v_max_f32 v241, v241, v19
    v_mov_b32 v233, v118
    s_bitset0_b32 s98, 1
    v_lshlrev_b32 v166, 16, v110
    v_and_b32 v167, 0xffff0000, v110
    v_lshlrev_b32 v168, 16, v111
    v_and_b32 v169, 0xffff0000, v111
    v_lshlrev_b32 v170, 16, v112
    v_and_b32 v171, 0xffff0000, v112
    v_lshlrev_b32 v172, 16, v113
    v_and_b32 v173, 0xffff0000, v113
    v_lshlrev_b32 v174, 16, v114
    v_and_b32 v175, 0xffff0000, v114
    v_lshlrev_b32 v176, 16, v115
    v_and_b32 v177, 0xffff0000, v115
    v_lshlrev_b32 v178, 16, v116
    v_and_b32 v179, 0xffff0000, v116
    v_lshlrev_b32 v180, 16, v117
    v_and_b32 v181, 0xffff0000, v117
L_nock_29:
    s_bitcmp1_b32 s98, 2
    s_cbranch_scc0 L_nock_30
    v_add3_u32 v19, v128, s99, v120
    v_add3_u32 v13, v121, v122, v123
    v_add3_u32 v19, v19, v124, v125
    v_add3_u32 v13, v13, v126, v127
    v_add_u32 v19, v19, v13
    v_cmp_ne_u32 vcc, v19, v129
    v_sub_f32 v19, v128, v253
    s_cmp_lg_u64 vcc, 0
    s_cbranch_scc1 L_nock_30
    v_exp_f32 v234, v19
    v_max_f32 v241, v241, v19
    v_mov_b32 v235, v128
    s_bitset0_b32 s98, 2
    v_lshlrev_b32 v182, 16, v120
    v_and_b32 v183, 0xffff0000, v120
    v_lshlrev_b32 v184, 16, v121
    v_and_b32 v185, 0xffff0000, v121
    v_lshlrev_b32 v186, 16, v122
    v_and_b32 v187, 0xffff0000, v122
    v_lshlrev_b32 v188, 16, v123
    v_and_b32 v189, 0xffff0000, v123
    v_lshlrev_b32 v190, 16, v124
    v_and_b32 v191, 0xffff0000, v124
    v_lshlrev_b32 v192, 16, v125
    v_and_b32 v193, 0xffff0000, v125
    v_lshlrev_b32 v194, 16, v126
    v_and_b32 v195, 0xffff0000, v126
    v_lshlrev_b32 v196, 16, v127
    v_and_b32 v197, 0xffff0000, v127
L_nock_30:
    s_bitcmp1_b32 s98, 3
    s_cbranch_scc0 L_nock_31
    v_add3_u32 v19, v138, s99, v130
    v_add3_u32 v13, v131, v132, v133
    v_add3_u32 v19, v19, v134, v135
    v_add3_u32 v13, v13, v136, v137
    v_add_u32 v19, v19, v13
    v_cmp_ne_u32 vcc, v19, v139
    v_sub_f32 v19, v138, v253
    s_cmp_lg_u64 vcc, 0
    s_cbranch_scc1 L_nock_31
    v_exp_f32 v236, v19
    v_max_f32 v241, v241, v19
    v_mov_b32 v237, v138
    s_bitset0_b32 s98, 3
    v_lshlrev_b32 v198, 16, v130
    v_and_b32 v199, 0xffff0000, v130
    v_lshlrev_b32 v200, 16, v131
    v_and_b32 v201, 0xffff0000, v131
    v_lshlrev_b32 v202, 16, v132
    v_and_b32 v203, 0xffff0000, v132
    v_lshlrev_b32 v204, 16, v133
    v_and_b32 v205, 0xffff0000, v133
    v_lshlrev_b32 v206, 16, v134
    v_and_b32 v207, 0xffff0000, v134
    v_lshlrev_b32 v208, 16, v135
    v_and_b32 v209, 0xffff0000, v135
    v_lshlrev_b32 v210, 16, v136
    v_and_b32 v211, 0xffff0000, v136
    v_lshlrev_b32 v212, 16, v137
    v_and_b32 v213, 0xffff0000, v137
L_nock_31:
    s_bitcmp1_b32 s98, 4
    s_cbranch_scc0 L_nock_32
    v_add3_u32 v19, v148, s99, v140
    v_add3_u32 v13, v141, v142, v143
    v_add3_u32 v19, v19, v144, v145
    v_add3_u32 v13, v13, v146, v147
    v_add_u32 v19, v19, v13
    v_cmp_ne_u32 vcc, v19, v149
    v_sub_f32 v19, v148, v253
    s_cmp_lg_u64 vcc, 0
    s_cbranch_scc1 L_nock_32
    v_exp_f32 v238, v19
    v_max_f32 v241, v241, v19
    v_mov_b32 v239, v148
    s_bitset0_b32 s98, 4
    v_lshlrev_b32 v214, 16, v140
    v_and_b32 v215, 0xffff0000, v140
    v_lshlrev_b32 v216, 16, v141
    v_and_b32 v217, 0xffff0000, v141
    v_lshlrev_b32 v218, 16, v142
    v_and_b32 v219, 0xffff0000, v142
    v_lshlrev_b32 v220, 16, v143
    v_and_b32 v221, 0xffff0000, v143
    v_lshlrev_b32 v222, 16, v144
    v_and_b32 v223, 0xffff0000, v144
    v_lshlrev_b32 v224, 16, v145
    v_and_b32 v225, 0xffff0000, v145
    v_lshlrev_b32 v226, 16, v146
    v_and_b32 v227, 0xffff0000, v146
    v_lshlrev_b32 v228, 16, v147
    v_and_b32 v229, 0xffff0000, v147
L_nock_32:
    s_cmp_eq_u32 s98, 0
    s_cbranch_scc1 L_merge
L_round:
    s_waitcnt vmcnt(0)
    s_bitcmp1_b32 s98, 0
    s_cbranch_scc0 L_nock_33
    v_add3_u32 v19, v28, s99, v20
    v_add3_u32 v13, v21, v22, v23
    v_add3_u32 v19, v19, v24, v25
    v_add3_u32 v13, v13, v26, v27
    v_add_u32 v19, v19, v13
    v_cmp_ne_u32 vcc, v19, v29
    v_sub_f32 v19, v28, v253
    s_cmp_lg_u64 vcc, 0
    s_cbranch_scc1 L_nock_33
    v_exp_f32 v230, v19
    v_max_f32 v241, v241, v19
    v_mov_b32 v231, v28
    s_bitset0_b32 s98, 0
    v_lshlrev_b32 v150, 16, v20
    v_and_b32 v151, 0xffff0000, v20
    v_lshlrev_b32 v152, 16, v21
    v_and_b32 v153, 0xffff0000, v21
    v_lshlrev_b32 v154, 16, v22
    v_and_b32 v155, 0xffff0000, v22
    v_lshlrev_b32 v156, 16, v23
    v_and_b32 v157, 0xffff0000, v23
    v_lshlrev_b32 v158, 16, v24
    v_and_b32 v159, 0xffff0000, v24
    v_lshlrev_b32 v160, 16, v25
    v_and_b32 v161, 0xffff0000, v25
    v_lshlrev_b32 v162, 16, v26
    v_and_b32 v163, 0xffff0000, v26
    v_lshlrev_b32 v164, 16, v27
    v_and_b32 v165, 0xffff0000, v27
L_nock_33:
    s_bitcmp1_b32 s98, 1
    s_cbranch_scc0 L_nock_34
    v_add3_u32 v19, v38, s99, v30
    v_add3_u32 v13, v31, v32, v33
    v_add3_u32 v19, v19, v34, v35
    v_add3_u32 v13, v13, v36, v37
    v_add_u32 v19, v19, v13
    v_cmp_ne_u32 vcc, v19, v39
    v_sub_f32 v19, v38, v253
    s_cmp_lg_u64 vcc, 0
    s_cbranch_scc1 L_nock_34
    v_exp_f32 v232, v19
    v_max_f32 v241, v241, v19
    v_mov_b32 v233, v38
    s_bitset0_b32 s98, 1
    v_lshlrev_b32 v166, 16, v30
    v_and_b32 v167, 0xffff0000, v30
    v_lshlrev_b32 v168, 16, v31
    v_and_b32 v169, 0xffff0000, v31
    v_lshlrev_b32 v170, 16, v32
    v_and_b32 v171, 0xffff0000, v32
    v_lshlrev_b32 v172, 16, v33
    v_and_b32 v173, 0xffff0000, v33
    v_lshlrev_b32 v174, 16, v34
    v_and_b32 v175, 0xffff0000, v34
    v_lshlrev_b32 v176, 16, v35
    v_and_b32 v177, 0xffff0000, v35
    v_lshlrev_b32 v178, 16, v36
    v_and_b32 v179, 0xffff0000, v36
    v_lshlrev_b32 v180, 16, v37
    v_and_b32 v181, 0xffff0000, v37
L_nock_34:
    s_bitcmp1_b32 s98, 2
    s_cbranch_scc0 L_nock_35
    v_add3_u32 v19, v48, s99, v40
    v_add3_u32 v13, v41, v42, v43
    v_add3_u32 v19, v19, v44, v45
    v_add3_u32 v13, v13, v46, v47
    v_add_u32 v19, v19, v13
    v_cmp_ne_u32 vcc, v19, v49
    v_sub_f32 v19, v48, v253
    s_cmp_lg_u64 vcc, 0
    s_cbranch_scc1 L_nock_35
    v_exp_f32 v234, v19
    v_max_f32 v241, v241, v19
    v_mov_b32 v235, v48
    s_bitset0_b32 s98, 2
    v_lshlrev_b32 v182, 16, v40
    v_and_b32 v183, 0xffff0000, v40
    v_lshlrev_b32 v184, 16, v41
    v_and_b32 v185, 0xffff0000, v41
    v_lshlrev_b32 v186, 16, v42
    v_and_b32 v187, 0xffff0000, v42
    v_lshlrev_b32 v188, 16, v43
    v_and_b32 v189, 0xffff0000, v43
    v_lshlrev_b32 v190, 16, v44
    v_and_b32 v191, 0xffff0000, v44
    v_lshlrev_b32 v192, 16, v45
    v_and_b32 v193, 0xffff0000, v45
    v_lshlrev_b32 v194, 16, v46
    v_and_b32 v195, 0xffff0000, v46
    v_lshlrev_b32 v196, 16, v47
    v_and_b32 v197, 0xffff0000, v47
L_nock_35:
    s_bitcmp1_b32 s98, 3
    s_cbranch_scc0 L_nock_36
    v_add3_u32 v19, v58, s99, v50
    v_add3_u32 v13, v51, v52, v53
    v_add3_u32 v19, v19, v54, v55
    v_add3_u32 v13, v13, v56, v57
    v_add_u32 v19, v19, v13
    v_cmp_ne_u32 vcc, v19, v59
    v_sub_f32 v19, v58, v253
    s_cmp_lg_u64 vcc, 0
    s_cbranch_scc1 L_nock_36
    v_exp_f32 v236, v19
    v_max_f32 v241, v241, v19
    v_mov_b32 v237, v58
    s_bitset0_b32 s98, 3
    v_lshlrev_b32 v198, 16, v50
    v_and_b32 v199, 0xffff0000, v50
    v_lshlrev_b32 v200, 16, v51
    v_and_b32 v201, 0xffff0000, v51
    v_lshlrev_b32 v202, 16, v52
    v_and_b32 v203, 0xffff0000, v52
    v_lshlrev_b32 v204, 16, v53
    v_and_b32 v205, 0xffff0000, v53
    v_lshlrev_b32 v206, 16, v54
    v_and_b32 v207, 0xffff0000, v54
    v_lshlrev_b32 v208, 16, v55
    v_and_b32 v209, 0xffff0000, v55
    v_lshlrev_b32 v210, 16, v56
    v_and_b32 v211, 0xffff0000, v56
    v_lshlrev_b32 v212, 16, v57
    v_and_b32 v213, 0xffff0000, v57
L_nock_36:
    s_bitcmp1_b32 s98, 4
    s_cbranch_scc0 L_nock_37
    v_add3_u32 v19, v68, s99, v60
    v_add3_u32 v13, v61, v62, v63
    v_add3_u32 v19, v19, v64, v65
    v_add3_u32 v13, v13, v66, v67
    v_add_u32 v19, v19, v13
    v_cmp_ne_u32 vcc, v19, v69
    v_sub_f32 v19, v68, v253
    s_cmp_lg_u64 vcc, 0
    s_cbranch_scc1 L_nock_37
    v_exp_f32 v238, v19
    v_max_f32 v241, v241, v19
    v_mov_b32 v239, v68
    s_bitset0_b32 s98, 4
    v_lshlrev_b32 v214, 16, v60
    v_and_b32 v215, 0xffff0000, v60
    v_lshlrev_b32 v216, 16, v61
    v_and_b32 v217, 0xffff0000, v61
    v_lshlrev_b32 v218, 16, v62
    v_and_b32 v219, 0xffff0000, v62
    v_lshlrev_b32 v220, 16, v63
    v_and_b32 v221, 0xffff0000, v63
    v_lshlrev_b32 v222, 16, v64
    v_and_b32 v223, 0xffff0000, v64
    v_lshlrev_b32 v224, 16, v65
    v_and_b32 v225, 0xffff0000, v65
    v_lshlrev_b32 v226, 16, v66
    v_and_b32 v227, 0xffff0000, v66
    v_lshlrev_b32 v228, 16, v67
    v_and_b32 v229, 0xffff0000, v67
L_nock_37:
    s_cmp_eq_u32 s98, 0
    s_cbranch_scc1 L_merge
    s_sub_u32 s54, s54, 1
    s_cbranch_scc1 L_end
L_issue:
    s_bitcmp1_b32 s98, 0
    s_cbranch_scc0 L_nold_38
    buffer_load_dwordx4 v[20:23], v245, s[24:27], s55 offen sc1
    buffer_load_dwordx4 v[24:27], v245, s[24:27], s55 offen offset:1024 sc1
    buffer_load_dwordx2 v[28:29], v246, s[24:27], s55 offen offset:2048 sc1
L_nold_38:
    s_bitcmp1_b32 s98, 1
    s_cbranch_scc0 L_nold_39
    buffer_load_dwordx4 v[30:33], v245, s[24:27], s56 offen sc1
    buffer_load_dwordx4 v[34:37], v245, s[24:27], s56 offen offset:1024 sc1
    buffer_load_dwordx2 v[38:39], v246, s[24:27], s56 offen offset:2048 sc1
L_nold_39:
    s_bitcmp1_b32 s98, 2
    s_cbranch_scc0 L_nold_40
    buffer_load_dwordx4 v[40:43], v245, s[24:27], s57 offen sc1
    buffer_load_dwordx4 v[44:47], v245, s[24:27], s57 offen offset:1024 sc1
    buffer_load_dwordx2 v[48:49], v246, s[24:27], s57 offen offset:2048 sc1
L_nold_40:
    s_bitcmp1_b32 s98, 3
    s_cbranch_scc0 L_nold_41
    buffer_load_dwordx4 v[50:53], v245, s[24:27], s58 offen sc1
    buffer_load_dwordx4 v[54:57], v245, s[24:27], s58 offen offset:1024 sc1
    buffer_load_dwordx2 v[58:59], v246, s[24:27], s58 offen offset:2048 sc1
L_nold_41:
    s_bitcmp1_b32 s98, 4
    s_cbranch_scc0 L_nold_42
    buffer_load_dwordx4 v[60:63], v245, s[24:27], s59 offen sc1
    buffer_load_dwordx4 v[64:67], v245, s[24:27], s59 offen offset:1024 sc1
    buffer_load_dwordx2 v[68:69], v246, s[24:27], s59 offen offset:2048 sc1
L_nold_42:
    s_branch L_round
L_merge:
    v_add_f32 v240, 1.0, v230
    v_cmp_nge_f32 vcc, 0x42700000, v241
    v_add_f32 v240, v240, v232
    v_add_f32 v240, v240, v234
    v_add_f32 v240, v240, v236
    v_add_f32 v240, v240, v238
    s_cmp_gt_u32 s82, 6
    s_cbranch_scc1 L_slowmerge
    s_cmp_lg_u64 vcc, 0
    s_cbranch_scc1 L_slowmerge
    v_rcp_f32 v240, v240
    v_pk_fma_f32 v[84:85], v[150:151], v[230:231], v[84:85] op_sel_hi:[1,0,1]
    v_pk_fma_f32 v[86:87], v[152:153], v[230:231], v[86:87] op_sel_hi:[1,0,1]
    v_pk_fma_f32 v[88:89], v[154:155], v[230:231], v[88:89] op_sel_hi:[1,0,1]
    v_pk_fma_f32 v[90:91], v[156:157], v[230:231], v[90:91] op_sel_hi:[1,0,1]
    v_pk_fma_f32 v[92:93], v[158:159], v[230:231], v[92:93] op_sel_hi:[1,0,1]
    v_pk_fma_f32 v[94:95], v[160:161], v[230:231], v[94:95] op_sel_hi:[1,0,1]
    v_pk_fma_f32 v[96:97], v[162:163], v[230:231], v[96:97] op_sel_hi:[1,0,1]
    v_pk_fma_f32 v[98:99], v[164:165], v[230:231], v[98:99] op_sel_hi:[1,0,1]
    s_bitcmp1_b32 s92, 1
    s_cbranch_scc0 L_merged
    v_pk_fma_f32 v[84:85], v[166:167], v[232:233], v[84:85] op_sel_hi:[1,0,1]
    v_pk_fma_f32 v[86:87], v[168:169], v[232:233], v[86:87] op_sel_hi:[1,0,1]
    v_pk_fma_f32 v[88:89], v[170:171], v[232:233], v[88:89] op_sel_hi:[1,0,1]
    v_pk_fma_f32 v[90:91], v[172:173], v[232:233], v[90:91] op_sel_hi:[1,0,1]
    v_pk_fma_f32 v[92:93], v[174:175], v[232:233], v[92:93] op_sel_hi:[1,0,1]
    v_pk_fma_f32 v[94:95], v[176:177], v[232:233], v[94:95] op_sel_hi:[1,0,1]
    v_pk_fma_f32 v[96:97], v[178:179], v[232:233], v[96:97] op_sel_hi:[1,0,1]
    v_pk_fma_f32 v[98:99], v[180:181], v[232:233], v[98:99] op_sel_hi:[1,0,1]
    s_bitcmp1_b32 s92, 2
    s_cbranch_scc0 L_merged
    v_pk_fma_f32 v[84:85], v[182:183], v[234:235], v[84:85] op_sel_hi:[1,0,1]
    v_pk_fma_f32 v[86:87], v[184:185], v[234:235], v[86:87] op_sel_hi:[1,0,1]
    v_pk_fma_f32 v[88:89], v[186:187], v[234:235], v[88:89] op_sel_hi:[1,0,1]
    v_pk_fma_f32 v[90:91], v[188:189], v[234:235], v[90:91] op_sel_hi:[1,0,1]
    v_pk_fma_f32 v[92:93], v[190:191], v[234:235], v[92:93] op_sel_hi:[1,0,1]
    v_pk_fma_f32 v[94:95], v[192:193], v[234:235], v[94:95] op_sel_hi:[1,0,1]
    v_pk_fma_f32 v[96:97], v[194:195], v[234:235], v[96:97] op_sel_hi:[1,0,1]
    v_pk_fma_f32 v[98:99], v[196:197], v[234:235], v[98:99] op_sel_hi:[1,0,1]
    s_bitcmp1_b32 s92, 3
    s_cbranch_scc0 L_merged
    v_pk_fma_f32 v[84:85], v[198:199], v[236:237], v[84:85] op_sel_hi:[1,0,1]
    v_pk_fma_f32 v[86:87], v[200:201], v[236:237], v[86:87] op_sel_hi:[1,0,1]
    v_pk_fma_f32 v[88:89], v[202:203], v[236:237], v[88:89] op_sel_hi:[1,0,1]
    v_pk_fma_f32 v[90:91], v[204:205], v[236:237], v[90:91] op_sel_hi:[1,0,1]
    v_pk_fma_f32 v[92:93], v[206:207], v[236:237], v[92:93] op_sel_hi:[1,0,1]
    v_pk_fma_f32 v[94:95], v[208:209], v[236:237], v[94:95] op_sel_hi:[1,0,1]
    v_pk_fma_f32 v[96:97], v[210:211], v[236:237], v[96:97] op_sel_hi:[1,0,1]
    v_pk_fma_f32 v[98:99], v[212:213], v[236:237], v[98:99] op_sel_hi:[1,0,1]
    s_bitcmp1_b32 s92, 4
    s_cbranch_scc0 L_merged
    v_pk_fma_f32 v[84:85], v[214:215], v[238:239], v[84:85] op_sel_hi:[1,0,1]
    v_pk_fma_f32 v[86:87], v[216:217], v[238:239], v[86:87] op_sel_hi:[1,0,1]
    v_pk_fma_f32 v[88:89], v[218:219], v[238:239], v[88:89] op_sel_hi:[1,0,1]
    v_pk_fma_f32 v[90:91], v[220:221], v[238:239], v[90:91] op_sel_hi:[1,0,1]
    v_pk_fma_f32 v[92:93], v[222:223], v[238:239], v[92:93] op_sel_hi:[1,0,1]
    v_pk_fma_f32 v[94:95], v[224:225], v[238:239], v[94:95] op_sel_hi:[1,0,1]
    v_pk_fma_f32 v[96:97], v[226:227], v[238:239], v[96:97] op_sel_hi:[1,0,1]
    v_pk_fma_f32 v[98:99], v[228:229], v[238:239], v[98:99] op_sel_hi:[1,0,1]
L_merged:
    v_pk_mul_f32 v[84:85], v[84:85], v[240:241] op_sel_hi:[1,0]
    v_pk_mul_f32 v[86:87], v[86:87], v[240:241] op_sel_hi:[1,0]
    v_pk_mul_f32 v[88:89], v[88:89], v[240:241] op_sel_hi:[1,0]
    v_pk_mul_f32 v[90:91], v[90:91], v[240:241] op_sel_hi:[1,0]
    v_pk_mul_f32 v[92:93], v[92:93], v[240:241] op_sel_hi:[1,0]
    v_pk_mul_f32 v[94:95], v[94:95], v[240:241] op_sel_hi:[1,0]
    v_pk_mul_f32 v[96:97], v[96:97], v[240:241] op_sel_hi:[1,0]
    v_pk_mul_f32 v[98:99], v[98:99], v[240:241] op_sel_hi:[1,0]
L_final:
    v_cvt_pk_bf16_f32 v70, v84, v85
    v_cvt_pk_bf16_f32 v71, v86, v87
    v_cvt_pk_bf16_f32 v72, v88, v89
    v_cvt_pk_bf16_f32 v73, v90, v91
    v_cvt_pk_bf16_f32 v74, v92, v93
    v_cvt_pk_bf16_f32 v75, v94, v95
    v_cvt_pk_bf16_f32 v76, v96, v97
    v_cvt_pk_bf16_f32 v77, v98, v99
    s_nop 1
    v_permlane32_swap_b32 v70, v72
    v_permlane32_swap_b32 v71, v73
    v_permlane32_swap_b32 v74, v76
    v_permlane32_swap_b32 v75, v77
    buffer_store_dwordx4 v[70:73], v10, s[28:31], s67 offen offset:0
    buffer_store_dwordx4 v[74:77], v10, s[28:31], s67 offen offset:32
L_segnext:
    s_add_u32 s41, s47, s40
    s_add_u32 s43, s43, 1
    s_cmp_lt_u32 s41, s42
    s_cbranch_scc0 L_end
    v_readlane_b32 s44, v3, s43
    v_readlane_b32 s45, v2, s43
    s_sub_u32 s46, s44, s45
    s_max_u32 s41, s41, s46
    s_sub_u32 s46, s41, s46
    s_min_u32 s47, s44, s42
    s_sub_u32 s48, s47, s41
    s_add_u32 s49, s48, 7
    s_lshr_b32 s49, s49, 3
    v_mov_b32 v19, 158976
    v_cmp_lt_u32 vcc, v17, v19
    v_mov_b32 v19, 0xfffff800
    v_mov_b32 v249, 0x800
    v_cndmask_b32 v19, v19, v249, vcc
    v_add_u32 v17, v17, v19
    v_add_u32 v16, v16, v19
    s_branch L_cseg
L_qflag:
    s_waitcnt vmcnt(0)
    s_add_u32 s50, s75, 1
    v_mov_b32 v249, s50
    s_mov_b64 exec, 1
    ds_write_b32 v15, v249 offset:288
    s_mov_b64 exec, -1
    s_branch L_qflag_done
L_hook:
    s_cmp_eq_u32 s61, 0
    s_cbranch_scc1 L_hookp
    s_mov_b32 s93, -1
    s_bitcmp1_b32 s98, 0
    s_cbranch_scc0 L_nold_43
    buffer_load_dwordx4 v[100:103], v245, s[24:27], s55 offen sc1
    buffer_load_dwordx4 v[104:107], v245, s[24:27], s55 offen offset:1024 sc1
    buffer_load_dwordx2 v[108:109], v246, s[24:27], s55 offen offset:2048 sc1
L_nold_43:
    s_bitcmp1_b32 s98, 1
    s_cbranch_scc0 L_nold_44
    buffer_load_dwordx4 v[110:113], v245, s[24:27], s56 offen sc1
    buffer_load_dwordx4 v[114:117], v245, s[24:27], s56 offen offset:1024 sc1
    buffer_load_dwordx2 v[118:119], v246, s[24:27], s56 offen offset:2048 sc1
L_nold_44:
    s_bitcmp1_b32 s98, 2
    s_cbranch_scc0 L_nold_45
    buffer_load_dwordx4 v[120:123], v245, s[24:27], s57 offen sc1
    buffer_load_dwordx4 v[124:127], v245, s[24:27], s57 offen offset:1024 sc1
    buffer_load_dwordx2 v[128:129], v246, s[24:27], s57 offen offset:2048 sc1
L_nold_45:
    s_bitcmp1_b32 s98, 3
    s_cbranch_scc0 L_nold_46
    buffer_load_dwordx4 v[130:133], v245, s[24:27], s58 offen sc1
    buffer_load_dwordx4 v[134:137], v245, s[24:27], s58 offen offset:1024 sc1
    buffer_load_dwordx2 v[138:139], v246, s[24:27], s58 offen offset:2048 sc1
L_nold_46:
    s_bitcmp1_b32 s98, 4
    s_cbranch_scc0 L_nold_47
    buffer_load_dwordx4 v[140:143], v245, s[24:27], s59 offen sc1
    buffer_load_dwordx4 v[144:147], v245, s[24:27], s59 offen offset:1024 sc1
    buffer_load_dwordx2 v[148:149], v246, s[24:27], s59 offen offset:2048 sc1
L_nold_47:
    s_branch L_pv4
L_hookp:
    s_waitcnt vmcnt(0)
    v_readfirstlane_b32 s50, v242
    v_readfirstlane_b32 s51, v243
    s_mov_b32 s93, -1
    s_xor_b32 s50, s50, s99
    s_xor_b32 s51, s51, s32
    s_or_b32 s50, s50, s51
    s_cselect_b32 s91, 0, 1
    s_branch L_pv4
L_slowmerge:
    s_cmp_gt_u32 s83, 6
    s_cbranch_scc1 L_slow1
    v_mov_b32 v12, 1.0
L_slow1:
    v_max3_f32 v19, v253, v231, v233
    v_max3_f32 v19, v19, v235, v237
    v_max_f32 v19, v19, v239
    v_sub_f32 v240, v253, v19
    v_sub_f32 v230, v231, v19
    v_sub_f32 v232, v233, v19
    v_sub_f32 v234, v235, v19
    v_sub_f32 v236, v237, v19
    v_sub_f32 v238, v239, v19
    v_exp_f32 v240, v240
    v_exp_f32 v230, v230
    v_exp_f32 v232, v232
    v_exp_f32 v234, v234
    v_exp_f32 v236, v236
    v_exp_f32 v238, v238
    v_mov_b32 v253, v19
    v_mul_f32 v12, v12, v240
    v_pk_mul_f32 v[84:85], v[84:85], v[240:241] op_sel_hi:[1,0]
    v_pk_mul_f32 v[86:87], v[86:87], v[240:241] op_sel_hi:[1,0]
    v_pk_mul_f32 v[88:89], v[88:89], v[240:241] op_sel_hi:[1,0]
    v_pk_mul_f32 v[90:91], v[90:91], v[240:241] op_sel_hi:[1,0]
    v_pk_mul_f32 v[92:93], v[92:93], v[240:241] op_sel_hi:[1,0]
    v_pk_mul_f32 v[94:95], v[94:95], v[240:241] op_sel_hi:[1,0]
    v_pk_mul_f32 v[96:97], v[96:97], v[240:241] op_sel_hi:[1,0]
    v_pk_mul_f32 v[98:99], v[98:99], v[240:241] op_sel_hi:[1,0]
    v_add_f32 v12, v12, v230
    v_pk_fma_f32 v[84:85], v[150:151], v[230:231], v[84:85] op_sel_hi:[1,0,1]
    v_pk_fma_f32 v[86:87], v[152:153], v[230:231], v[86:87] op_sel_hi:[1,0,1]
    v_pk_fma_f32 v[88:89], v[154:155], v[230:231], v[88:89] op_sel_hi:[1,0,1]
    v_pk_fma_f32 v[90:91], v[156:157], v[230:231], v[90:91] op_sel_hi:[1,0,1]
    v_pk_fma_f32 v[92:93], v[158:159], v[230:231], v[92:93] op_sel_hi:[1,0,1]
    v_pk_fma_f32 v[94:95], v[160:161], v[230:231], v[94:95] op_sel_hi:[1,0,1]
    v_pk_fma_f32 v[96:97], v[162:163], v[230:231], v[96:97] op_sel_hi:[1,0,1]
    v_pk_fma_f32 v[98:99], v[164:165], v[230:231], v[98:99] op_sel_hi:[1,0,1]
    s_bitcmp1_b32 s92, 1
    s_cbranch_scc0 L_slow2
    v_add_f32 v12, v12, v232
    v_pk_fma_f32 v[84:85], v[166:167], v[232:233], v[84:85] op_sel_hi:[1,0,1]
    v_pk_fma_f32 v[86:87], v[168:169], v[232:233], v[86:87] op_sel_hi:[1,0,1]
    v_pk_fma_f32 v[88:89], v[170:171], v[232:233], v[88:89] op_sel_hi:[1,0,1]
    v_pk_fma_f32 v[90:91], v[172:173], v[232:233], v[90:91] op_sel_hi:[1,0,1]
    v_pk_fma_f32 v[92:93], v[174:175], v[232:233], v[92:93] op_sel_hi:[1,0,1]
    v_pk_fma_f32 v[94:95], v[176:177], v[232:233], v[94:95] op_sel_hi:[1,0,1]
    v_pk_fma_f32 v[96:97], v[178:179], v[232:233], v[96:97] op_sel_hi:[1,0,1]
    v_pk_fma_f32 v[98:99], v[180:181], v[232:233], v[98:99] op_sel_hi:[1,0,1]
    s_bitcmp1_b32 s92, 2
    s_cbranch_scc0 L_slow2
    v_add_f32 v12, v12, v234
    v_pk_fma_f32 v[84:85], v[182:183], v[234:235], v[84:85] op_sel_hi:[1,0,1]
    v_pk_fma_f32 v[86:87], v[184:185], v[234:235], v[86:87] op_sel_hi:[1,0,1]
    v_pk_fma_f32 v[88:89], v[186:187], v[234:235], v[88:89] op_sel_hi:[1,0,1]
    v_pk_fma_f32 v[90:91], v[188:189], v[234:235], v[90:91] op_sel_hi:[1,0,1]
    v_pk_fma_f32 v[92:93], v[190:191], v[234:235], v[92:93] op_sel_hi:[1,0,1]
    v_pk_fma_f32 v[94:95], v[192:193], v[234:235], v[94:95] op_sel_hi:[1,0,1]
    v_pk_fma_f32 v[96:97], v[194:195], v[234:235], v[96:97] op_sel_hi:[1,0,1]
    v_pk_fma_f32 v[98:99], v[196:197], v[234:235], v[98:99] op_sel_hi:[1,0,1]
    s_bitcmp1_b32 s92, 3
    s_cbranch_scc0 L_slow2
    v_add_f32 v12, v12, v236
    v_pk_fma_f32 v[84:85], v[198:199], v[236:237], v[84:85] op_sel_hi:[1,0,1]
    v_pk_fma_f32 v[86:87], v[200:201], v[236:237], v[86:87] op_sel_hi:[1,0,1]
    v_pk_fma_f32 v[88:89], v[202:203], v[236:237], v[88:89] op_sel_hi:[1,0,1]
    v_pk_fma_f32 v[90:91], v[204:205], v[236:237], v[90:91] op_sel_hi:[1,0,1]
    v_pk_fma_f32 v[92:93], v[206:207], v[236:237], v[92:93] op_sel_hi:[1,0,1]
    v_pk_fma_f32 v[94:95], v[208:209], v[236:237], v[94:95] op_sel_hi:[1,0,1]
    v_pk_fma_f32 v[96:97], v[210:211], v[236:237], v[96:97] op_sel_hi:[1,0,1]
    v_pk_fma_f32 v[98:99], v[212:213], v[236:237], v[98:99] op_sel_hi:[1,0,1]
    s_bitcmp1_b32 s92, 4
    s_cbranch_scc0 L_slow2
    v_add_f32 v12, v12, v238
    v_pk_fma_f32 v[84:85], v[214:215], v[238:239], v[84:85] op_sel_hi:[1,0,1]
    v_pk_fma_f32 v[86:87], v[216:217], v[238:239], v[86:87] op_sel_hi:[1,0,1]
    v_pk_fma_f32 v[88:89], v[218:219], v[238:239], v[88:89] op_sel_hi:[1,0,1]
    v_pk_fma_f32 v[90:91], v[220:221], v[238:239], v[90:91] op_sel_hi:[1,0,1]
    v_pk_fma_f32 v[92:93], v[222:223], v[238:239], v[92:93] op_sel_hi:[1,0,1]
    v_pk_fma_f32 v[94:95], v[224:225], v[238:239], v[94:95] op_sel_hi:[1,0,1]
    v_pk_fma_f32 v[96:97], v[226:227], v[238:239], v[96:97] op_sel_hi:[1,0,1]
    v_pk_fma_f32 v[98:99], v[228:229], v[238:239], v[98:99] op_sel_hi:[1,0,1]
L_slow2:
    s_cmp_eq_u32 s83, s63
    s_addc_u32 s83, s83, 0
    s_cmp_lt_u32 s83, s82
    s_cbranch_scc1 L_more
    v_rcp_f32 v240, v12
    s_branch L_merged
L_getnon:
    v_mov_b32 v249, 0
    s_mov_b32 s51, 64
L_getnon1:
    s_sub_u32 s54, s54, 1
    s_cbranch_scc1 L_end
    global_load_dword v19, v249, s[16:17] sc1
    s_memrealtime s[94:95]
    s_waitcnt vmcnt(0) lgkmcnt(0)
    v_readfirstlane_b32 s50, v19
    s_cmp_eq_u32 s50, 0
    s_cbranch_scc1 L_getnon1
    s_sub_u32 s52, s94, s50
    s_add_u32 s52, s52, 100
    s_and_b32 s52, s52, 0x7fffffff
    s_cmp_le_u32 s52, 1100
    s_cbranch_scc1 L_getnon2
    s_sub_u32 s51, s51, 1
    s_cbranch_scc0 L_getnon1
L_getnon2:
    v_mov_b32 v52, s50
    v_mov_b32 v53, s32
    s_lshl_b32 s50, s2, 6
    s_add_u32 s50, s50, 3276800
    s_mov_b64 exec, 1
    ds_write_b32 v14, v19 offset:304
    buffer_store_dwordx2 v[52:53], v249, s[24:27], s50 offen sc1
    s_mov_b64 exec, -1
    s_branch L_cseg
L_more:
    s_waitcnt vmcnt(0)
    s_mov_b32 s98, 0
    s_cmp_eq_u32 s83, s63
    s_addc_u32 s83, s83, 0
    s_add_u32 s50, s79, s83
    s_lshl_b32 s50, s50, 3
    s_add_u32 s50, s50, s37
    s_cmp_eq_u32 s83, 0
    s_cselect_b32 s50, s33, s50
    s_lshl_b32 s55, s50, 2
    s_add_u32 s55, s55, s64
    s_mul_i32 s55, s55, 2560
    s_cmp_lt_u32 s83, s82
    s_cselect_b32 s50, 1, 0
    s_or_b32 s98, s98, s50
    s_add_u32 s83, s83, 1
    s_cmp_eq_u32 s83, s63
    s_addc_u32 s83, s83, 0
    s_add_u32 s50, s79, s83
    s_lshl_b32 s50, s50, 3
    s_add_u32 s50, s50, s37
    s_cmp_eq_u32 s83, 0
    s_cselect_b32 s50, s33, s50
    s_lshl_b32 s56, s50, 2
    s_add_u32 s56, s56, s64
    s_mul_i32 s56, s56, 2560
    s_cmp_lt_u32 s83, s82
    s_cselect_b32 s50, 2, 0
    s_or_b32 s98, s98, s50
    s_add_u32 s83, s83, 1
    s_cmp_eq_u32 s83, s63
    s_addc_u32 s83, s83, 0
    s_add_u32 s50, s79, s83
    s_lshl_b32 s50, s50, 3
    s_add_u32 s50, s50, s37
    s_cmp_eq_u32 s83, 0
    s_cselect_b32 s50, s33, s50
    s_lshl_b32 s57, s50, 2
    s_add_u32 s57, s57, s64
    s_mul_i32 s57, s57, 2560
    s_cmp_lt_u32 s83, s82
    s_cselect_b32 s50, 4, 0
    s_or_b32 s98, s98, s50
    s_add_u32 s83, s83, 1
    s_cmp_eq_u32 s83, s63
    s_addc_u32 s83, s83, 0
    s_add_u32 s50, s79, s83
    s_lshl_b32 s50, s50, 3
    s_add_u32 s50, s50, s37
    s_cmp_eq_u32 s83, 0
    s_cselect_b32 s50, s33, s50
    s_lshl_b32 s58, s50, 2
    s_add_u32 s58, s58, s64
    s_mul_i32 s58, s58, 2560
    s_cmp_lt_u32 s83, s82
    s_cselect_b32 s50, 8, 0
    s_or_b32 s98, s98, s50
    s_add_u32 s83, s83, 1
    s_cmp_eq_u32 s83, s63
    s_addc_u32 s83, s83, 0
    s_add_u32 s50, s79, s83
    s_lshl_b32 s50, s50, 3
    s_add_u32 s50, s50, s37
    s_cmp_eq_u32 s83, 0
    s_cselect_b32 s50, s33, s50
    s_lshl_b32 s59, s50, 2
    s_add_u32 s59, s59, s64
    s_mul_i32 s59, s59, 2560
    s_cmp_lt_u32 s83, s82
    s_cselect_b32 s50, 16, 0
    s_or_b32 s98, s98, s50
    s_add_u32 s83, s83, 1
    s_mov_b32 s92, s98
    v_mov_b32 v241, 0
    v_mov_b32 v108, v18
    v_mov_b32 v109, v18
    v_mov_b32 v230, 0
    v_mov_b32 v231, v18
    v_mov_b64 v[100:101], 0
    v_mov_b64 v[102:103], 0
    v_mov_b64 v[104:105], 0
    v_mov_b64 v[106:107], 0
    v_mov_b32 v118, v18
    v_mov_b32 v119, v18
    v_mov_b32 v232, 0
    v_mov_b32 v233, v18
    v_mov_b64 v[110:111], 0
    v_mov_b64 v[112:113], 0
    v_mov_b64 v[114:115], 0
    v_mov_b64 v[116:117], 0
    v_mov_b32 v128, v18
    v_mov_b32 v129, v18
    v_mov_b32 v234, 0
    v_mov_b32 v235, v18
    v_mov_b64 v[120:121], 0
    v_mov_b64 v[122:123], 0
    v_mov_b64 v[124:125], 0
    v_mov_b64 v[126:127], 0
    v_mov_b32 v138, v18
    v_mov_b32 v139, v18
    v_mov_b32 v236, 0
    v_mov_b32 v237, v18
    v_mov_b64 v[130:131], 0
    v_mov_b64 v[132:133], 0
    v_mov_b64 v[134:135], 0
    v_mov_b64 v[136:137], 0
    v_mov_b32 v148, v18
    v_mov_b32 v149, v18
    v_mov_b32 v238, 0
    v_mov_b32 v239, v18
    v_mov_b64 v[140:141], 0
    v_mov_b64 v[142:143], 0
    v_mov_b64 v[144:145], 0
    v_mov_b64 v[146:147], 0
    s_branch L_issue
L_redo:
    v_mul_f32 v251, s76, v11
    v_mov_b32 v12, 0
    v_mov_b32 v13, 0
    s_mov_b32 s70, s64
    s_lshl_b32 s50, s64, 11
    v_add_u32 v248, s50, v9
    s_cmp_ge_u32 s70, s71
    s_cbranch_scc1 L_elast
    v_fma_f32 v68, v100, s76, -v251
    v_fma_f32 v69, v101, s76, -v251
    v_fma_f32 v70, v102, s76, -v251
    v_fma_f32 v71, v103, s76, -v251
    v_fma_f32 v72, v104, s76, -v251
    v_fma_f32 v73, v105, s76, -v251
    v_fma_f32 v74, v106, s76, -v251
    v_fma_f32 v75, v107, s76, -v251
    v_fma_f32 v76, v108, s76, -v251
    v_fma_f32 v77, v109, s76, -v251
    v_fma_f32 v78, v110, s76, -v251
    v_fma_f32 v79, v111, s76, -v251
    v_fma_f32 v80, v112, s76, -v251
    v_fma_f32 v81, v113, s76, -v251
    v_fma_f32 v82, v114, s76, -v251
    v_fma_f32 v83, v115, s76, -v251
    v_exp_f32 v68, v68
    v_exp_f32 v69, v69
    v_exp_f32 v70, v70
    v_exp_f32 v71, v71
    v_exp_f32 v72, v72
    v_exp_f32 v73, v73
    v_exp_f32 v74, v74
    v_exp_f32 v75, v75
    v_exp_f32 v76, v76
    v_exp_f32 v77, v77
    v_exp_f32 v78, v78
    v_exp_f32 v79, v79
    v_exp_f32 v80, v80
    v_exp_f32 v81, v81
    v_exp_f32 v82, v82
    v_exp_f32 v83, v83
    v_add_f32 v12, v12, v68
    v_add_f32 v13, v13, v69
    v_cvt_pk_bf16_f32 v52, v68, v69
    v_add_f32 v12, v12, v70
    v_add_f32 v13, v13, v71
    v_cvt_pk_bf16_f32 v53, v70, v71
    v_add_f32 v12, v12, v72
    v_add_f32 v13, v13, v73
    v_cvt_pk_bf16_f32 v54, v72, v73
    v_add_f32 v12, v12, v74
    v_add_f32 v13, v13, v75
    v_cvt_pk_bf16_f32 v55, v74, v75
    v_add_f32 v12, v12, v76
    v_add_f32 v13, v13, v77
    v_cvt_pk_bf16_f32 v56, v76, v77
    v_add_f32 v12, v12, v78
    v_add_f32 v13, v13, v79
    v_cvt_pk_bf16_f32 v57, v78, v79
    v_add_f32 v12, v12, v80
    v_add_f32 v13, v13, v81
    v_cvt_pk_bf16_f32 v58, v80, v81
    v_add_f32 v12, v12, v82
    v_add_f32 v13, v13, v83
    v_cvt_pk_bf16_f32 v59, v82, v83
    ds_write_b128 v248, v[52:55]
    ds_write_b128 v248, v[56:59] offset:1024
    v_add_u32 v248, 8192, v248
    s_add_u32 s70, s70, 4
    s_cmp_ge_u32 s70, s71
    s_cbranch_scc1 L_elast
    v_fma_f32 v68, v116, s76, -v251
    v_fma_f32 v69, v117, s76, -v251
    v_fma_f32 v70, v118, s76, -v251
    v_fma_f32 v71, v119, s76, -v251
    v_fma_f32 v72, v120, s76, -v251
    v_fma_f32 v73, v121, s76, -v251
    v_fma_f32 v74, v122, s76, -v251
    v_fma_f32 v75, v123, s76, -v251
    v_fma_f32 v76, v124, s76, -v251
    v_fma_f32 v77, v125, s76, -v251
    v_fma_f32 v78, v126, s76, -v251
    v_fma_f32 v79, v127, s76, -v251
    v_fma_f32 v80, v128, s76, -v251
    v_fma_f32 v81, v129, s76, -v251
    v_fma_f32 v82, v130, s76, -v251
    v_fma_f32 v83, v131, s76, -v251
    v_exp_f32 v68, v68
    v_exp_f32 v69, v69
    v_exp_f32 v70, v70
    v_exp_f32 v71, v71
    v_exp_f32 v72, v72
    v_exp_f32 v73, v73
    v_exp_f32 v74, v74
    v_exp_f32 v75, v75
    v_exp_f32 v76, v76
    v_exp_f32 v77, v77
    v_exp_f32 v78, v78
    v_exp_f32 v79, v79
    v_exp_f32 v80, v80
    v_exp_f32 v81, v81
    v_exp_f32 v82, v82
    v_exp_f32 v83, v83
    v_add_f32 v12, v12, v68
    v_add_f32 v13, v13, v69
    v_cvt_pk_bf16_f32 v52, v68, v69
    v_add_f32 v12, v12, v70
    v_add_f32 v13, v13, v71
    v_cvt_pk_bf16_f32 v53, v70, v71
    v_add_f32 v12, v12, v72
    v_add_f32 v13, v13, v73
    v_cvt_pk_bf16_f32 v54, v72, v73
    v_add_f32 v12, v12, v74
    v_add_f32 v13, v13, v75
    v_cvt_pk_bf16_f32 v55, v74, v75
    v_add_f32 v12, v12, v76
    v_add_f32 v13, v13, v77
    v_cvt_pk_bf16_f32 v56, v76, v77
    v_add_f32 v12, v12, v78
    v_add_f32 v13, v13, v79
    v_cvt_pk_bf16_f32 v57, v78, v79
    v_add_f32 v12, v12, v80
    v_add_f32 v13, v13, v81
    v_cvt_pk_bf16_f32 v58, v80, v81
    v_add_f32 v12, v12, v82
    v_add_f32 v13, v13, v83
    v_cvt_pk_bf16_f32 v59, v82, v83
    ds_write_b128 v248, v[52:55]
    ds_write_b128 v248, v[56:59] offset:1024
    v_add_u32 v248, 8192, v248
    s_add_u32 s70, s70, 4
    s_cmp_ge_u32 s70, s71
    s_cbranch_scc1 L_elast
    v_fma_f32 v68, v132, s76, -v251
    v_fma_f32 v69, v133, s76, -v251
    v_fma_f32 v70, v134, s76, -v251
    v_fma_f32 v71, v135, s76, -v251
    v_fma_f32 v72, v136, s76, -v251
    v_fma_f32 v73, v137, s76, -v251
    v_fma_f32 v74, v138, s76, -v251
    v_fma_f32 v75, v139, s76, -v251
    v_fma_f32 v76, v140, s76, -v251
    v_fma_f32 v77, v141, s76, -v251
    v_fma_f32 v78, v142, s76, -v251
    v_fma_f32 v79, v143, s76, -v251
    v_fma_f32 v80, v144, s76, -v251
    v_fma_f32 v81, v145, s76, -v251
    v_fma_f32 v82, v146, s76, -v251
    v_fma_f32 v83, v147, s76, -v251
    v_exp_f32 v68, v68
    v_exp_f32 v69, v69
    v_exp_f32 v70, v70
    v_exp_f32 v71, v71
    v_exp_f32 v72, v72
    v_exp_f32 v73, v73
    v_exp_f32 v74, v74
    v_exp_f32 v75, v75
    v_exp_f32 v76, v76
    v_exp_f32 v77, v77
    v_exp_f32 v78, v78
    v_exp_f32 v79, v79
    v_exp_f32 v80, v80
    v_exp_f32 v81, v81
    v_exp_f32 v82, v82
    v_exp_f32 v83, v83
    v_add_f32 v12, v12, v68
    v_add_f32 v13, v13, v69
    v_cvt_pk_bf16_f32 v52, v68, v69
    v_add_f32 v12, v12, v70
    v_add_f32 v13, v13, v71
    v_cvt_pk_bf16_f32 v53, v70, v71
    v_add_f32 v12, v12, v72
    v_add_f32 v13, v13, v73
    v_cvt_pk_bf16_f32 v54, v72, v73
    v_add_f32 v12, v12, v74
    v_add_f32 v13, v13, v75
    v_cvt_pk_bf16_f32 v55, v74, v75
    v_add_f32 v12, v12, v76
    v_add_f32 v13, v13, v77
    v_cvt_pk_bf16_f32 v56, v76, v77
    v_add_f32 v12, v12, v78
    v_add_f32 v13, v13, v79
    v_cvt_pk_bf16_f32 v57, v78, v79
    v_add_f32 v12, v12, v80
    v_add_f32 v13, v13, v81
    v_cvt_pk_bf16_f32 v58, v80, v81
    v_add_f32 v12, v12, v82
    v_add_f32 v13, v13, v83
    v_cvt_pk_bf16_f32 v59, v82, v83
    ds_write_b128 v248, v[52:55]
    ds_write_b128 v248, v[56:59] offset:1024
    v_add_u32 v248, 8192, v248
    s_add_u32 s70, s70, 4
    s_cmp_ge_u32 s70, s71
    s_cbranch_scc1 L_elast
    v_fma_f32 v68, v148, s76, -v251
    v_fma_f32 v69, v149, s76, -v251
    v_fma_f32 v70, v150, s76, -v251
    v_fma_f32 v71, v151, s76, -v251
    v_fma_f32 v72, v152, s76, -v251
    v_fma_f32 v73, v153, s76, -v251
    v_fma_f32 v74, v154, s76, -v251
    v_fma_f32 v75, v155, s76, -v251
    v_fma_f32 v76, v156, s76, -v251
    v_fma_f32 v77, v157, s76, -v251
    v_fma_f32 v78, v158, s76, -v251
    v_fma_f32 v79, v159, s76, -v251
    v_fma_f32 v80, v160, s76, -v251
    v_fma_f32 v81, v161, s76, -v251
    v_fma_f32 v82, v162, s76, -v251
    v_fma_f32 v83, v163, s76, -v251
    v_exp_f32 v68, v68
    v_exp_f32 v69, v69
    v_exp_f32 v70, v70
    v_exp_f32 v71, v71
    v_exp_f32 v72, v72
    v_exp_f32 v73, v73
    v_exp_f32 v74, v74
    v_exp_f32 v75, v75
    v_exp_f32 v76, v76
    v_exp_f32 v77, v77
    v_exp_f32 v78, v78
    v_exp_f32 v79, v79
    v_exp_f32 v80, v80
    v_exp_f32 v81, v81
    v_exp_f32 v82, v82
    v_exp_f32 v83, v83
    v_add_f32 v12, v12, v68
    v_add_f32 v13, v13, v69
    v_cvt_pk_bf16_f32 v52, v68, v69
    v_add_f32 v12, v12, v70
    v_add_f32 v13, v13, v71
    v_cvt_pk_bf16_f32 v53, v70, v71
    v_add_f32 v12, v12, v72
    v_add_f32 v13, v13, v73
    v_cvt_pk_bf16_f32 v54, v72, v73
    v_add_f32 v12, v12, v74
    v_add_f32 v13, v13, v75
    v_cvt_pk_bf16_f32 v55, v74, v75
    v_add_f32 v12, v12, v76
    v_add_f32 v13, v13, v77
    v_cvt_pk_bf16_f32 v56, v76, v77
    v_add_f32 v12, v12, v78
    v_add_f32 v13, v13, v79
    v_cvt_pk_bf16_f32 v57, v78, v79
    v_add_f32 v12, v12, v80
    v_add_f32 v13, v13, v81
    v_cvt_pk_bf16_f32 v58, v80, v81
    v_add_f32 v12, v12, v82
    v_add_f32 v13, v13, v83
    v_cvt_pk_bf16_f32 v59, v82, v83
    ds_write_b128 v248, v[52:55]
    ds_write_b128 v248, v[56:59] offset:1024
    v_add_u32 v248, 8192, v248
    s_add_u32 s70, s70, 4
    s_cmp_ge_u32 s70, s71
    s_cbranch_scc1 L_elast
    v_fma_f32 v68, v164, s76, -v251
    v_fma_f32 v69, v165, s76, -v251
    v_fma_f32 v70, v166, s76, -v251
    v_fma_f32 v71, v167, s76, -v251
    v_fma_f32 v72, v168, s76, -v251
    v_fma_f32 v73, v169, s76, -v251
    v_fma_f32 v74, v170, s76, -v251
    v_fma_f32 v75, v171, s76, -v251
    v_fma_f32 v76, v172, s76, -v251
    v_fma_f32 v77, v173, s76, -v251
    v_fma_f32 v78, v174, s76, -v251
    v_fma_f32 v79, v175, s76, -v251
    v_fma_f32 v80, v176, s76, -v251
    v_fma_f32 v81, v177, s76, -v251
    v_fma_f32 v82, v178, s76, -v251
    v_fma_f32 v83, v179, s76, -v251
    v_exp_f32 v68, v68
    v_exp_f32 v69, v69
    v_exp_f32 v70, v70
    v_exp_f32 v71, v71
    v_exp_f32 v72, v72
    v_exp_f32 v73, v73
    v_exp_f32 v74, v74
    v_exp_f32 v75, v75
    v_exp_f32 v76, v76
    v_exp_f32 v77, v77
    v_exp_f32 v78, v78
    v_exp_f32 v79, v79
    v_exp_f32 v80, v80
    v_exp_f32 v81, v81
    v_exp_f32 v82, v82
    v_exp_f32 v83, v83
    v_add_f32 v12, v12, v68
    v_add_f32 v13, v13, v69
    v_cvt_pk_bf16_f32 v52, v68, v69
    v_add_f32 v12, v12, v70
    v_add_f32 v13, v13, v71
    v_cvt_pk_bf16_f32 v53, v70, v71
    v_add_f32 v12, v12, v72
    v_add_f32 v13, v13, v73
    v_cvt_pk_bf16_f32 v54, v72, v73
    v_add_f32 v12, v12, v74
    v_add_f32 v13, v13, v75
    v_cvt_pk_bf16_f32 v55, v74, v75
    v_add_f32 v12, v12, v76
    v_add_f32 v13, v13, v77
    v_cvt_pk_bf16_f32 v56, v76, v77
    v_add_f32 v12, v12, v78
    v_add_f32 v13, v13, v79
    v_cvt_pk_bf16_f32 v57, v78, v79
    v_add_f32 v12, v12, v80
    v_add_f32 v13, v13, v81
    v_cvt_pk_bf16_f32 v58, v80, v81
    v_add_f32 v12, v12, v82
    v_add_f32 v13, v13, v83
    v_cvt_pk_bf16_f32 v59, v82, v83
    ds_write_b128 v248, v[52:55]
    ds_write_b128 v248, v[56:59] offset:1024
    v_add_u32 v248, 8192, v248
    s_add_u32 s70, s70, 4
    s_cmp_ge_u32 s70, s71
    s_cbranch_scc1 L_elast
    v_fma_f32 v68, v180, s76, -v251
    v_fma_f32 v69, v181, s76, -v251
    v_fma_f32 v70, v182, s76, -v251
    v_fma_f32 v71, v183, s76, -v251
    v_fma_f32 v72, v184, s76, -v251
    v_fma_f32 v73, v185, s76, -v251
    v_fma_f32 v74, v186, s76, -v251
    v_fma_f32 v75, v187, s76, -v251
    v_fma_f32 v76, v188, s76, -v251
    v_fma_f32 v77, v189, s76, -v251
    v_fma_f32 v78, v190, s76, -v251
    v_fma_f32 v79, v191, s76, -v251
    v_fma_f32 v80, v192, s76, -v251
    v_fma_f32 v81, v193, s76, -v251
    v_fma_f32 v82, v194, s76, -v251
    v_fma_f32 v83, v195, s76, -v251
    v_exp_f32 v68, v68
    v_exp_f32 v69, v69
    v_exp_f32 v70, v70
    v_exp_f32 v71, v71
    v_exp_f32 v72, v72
    v_exp_f32 v73, v73
    v_exp_f32 v74, v74
    v_exp_f32 v75, v75
    v_exp_f32 v76, v76
    v_exp_f32 v77, v77
    v_exp_f32 v78, v78
    v_exp_f32 v79, v79
    v_exp_f32 v80, v80
    v_exp_f32 v81, v81
    v_exp_f32 v82, v82
    v_exp_f32 v83, v83
    v_add_f32 v12, v12, v68
    v_add_f32 v13, v13, v69
    v_cvt_pk_bf16_f32 v52, v68, v69
    v_add_f32 v12, v12, v70
    v_add_f32 v13, v13, v71
    v_cvt_pk_bf16_f32 v53, v70, v71
    v_add_f32 v12, v12, v72
    v_add_f32 v13, v13, v73
    v_cvt_pk_bf16_f32 v54, v72, v73
    v_add_f32 v12, v12, v74
    v_add_f32 v13, v13, v75
    v_cvt_pk_bf16_f32 v55, v74, v75
    v_add_f32 v12, v12, v76
    v_add_f32 v13, v13, v77
    v_cvt_pk_bf16_f32 v56, v76, v77
    v_add_f32 v12, v12, v78
    v_add_f32 v13, v13, v79
    v_cvt_pk_bf16_f32 v57, v78, v79
    v_add_f32 v12, v12, v80
    v_add_f32 v13, v13, v81
    v_cvt_pk_bf16_f32 v58, v80, v81
    v_add_f32 v12, v12, v82
    v_add_f32 v13, v13, v83
    v_cvt_pk_bf16_f32 v59, v82, v83
    ds_write_b128 v248, v[52:55]
    ds_write_b128 v248, v[56:59] offset:1024
    v_add_u32 v248, 8192, v248
    s_add_u32 s70, s70, 4
    s_cmp_ge_u32 s70, s71
    s_cbranch_scc1 L_elast
    v_fma_f32 v68, v196, s76, -v251
    v_fma_f32 v69, v197, s76, -v251
    v_fma_f32 v70, v198, s76, -v251
    v_fma_f32 v71, v199, s76, -v251
    v_fma_f32 v72, v200, s76, -v251
    v_fma_f32 v73, v201, s76, -v251
    v_fma_f32 v74, v202, s76, -v251
    v_fma_f32 v75, v203, s76, -v251
    v_fma_f32 v76, v204, s76, -v251
    v_fma_f32 v77, v205, s76, -v251
    v_fma_f32 v78, v206, s76, -v251
    v_fma_f32 v79, v207, s76, -v251
    v_fma_f32 v80, v208, s76, -v251
    v_fma_f32 v81, v209, s76, -v251
    v_fma_f32 v82, v210, s76, -v251
    v_fma_f32 v83, v211, s76, -v251
    v_exp_f32 v68, v68
    v_exp_f32 v69, v69
    v_exp_f32 v70, v70
    v_exp_f32 v71, v71
    v_exp_f32 v72, v72
    v_exp_f32 v73, v73
    v_exp_f32 v74, v74
    v_exp_f32 v75, v75
    v_exp_f32 v76, v76
    v_exp_f32 v77, v77
    v_exp_f32 v78, v78
    v_exp_f32 v79, v79
    v_exp_f32 v80, v80
    v_exp_f32 v81, v81
    v_exp_f32 v82, v82
    v_exp_f32 v83, v83
    v_add_f32 v12, v12, v68
    v_add_f32 v13, v13, v69
    v_cvt_pk_bf16_f32 v52, v68, v69
    v_add_f32 v12, v12, v70
    v_add_f32 v13, v13, v71
    v_cvt_pk_bf16_f32 v53, v70, v71
    v_add_f32 v12, v12, v72
    v_add_f32 v13, v13, v73
    v_cvt_pk_bf16_f32 v54, v72, v73
    v_add_f32 v12, v12, v74
    v_add_f32 v13, v13, v75
    v_cvt_pk_bf16_f32 v55, v74, v75
    v_add_f32 v12, v12, v76
    v_add_f32 v13, v13, v77
    v_cvt_pk_bf16_f32 v56, v76, v77
    v_add_f32 v12, v12, v78
    v_add_f32 v13, v13, v79
    v_cvt_pk_bf16_f32 v57, v78, v79
    v_add_f32 v12, v12, v80
    v_add_f32 v13, v13, v81
    v_cvt_pk_bf16_f32 v58, v80, v81
    v_add_f32 v12, v12, v82
    v_add_f32 v13, v13, v83
    v_cvt_pk_bf16_f32 v59, v82, v83
    ds_write_b128 v248, v[52:55]
    ds_write_b128 v248, v[56:59] offset:1024
    v_add_u32 v248, 8192, v248
    s_add_u32 s70, s70, 4
    s_cmp_ge_u32 s70, s71
    s_cbranch_scc1 L_elast
    v_fma_f32 v68, v212, s76, -v251
    v_fma_f32 v69, v213, s76, -v251
    v_fma_f32 v70, v214, s76, -v251
    v_fma_f32 v71, v215, s76, -v251
    v_fma_f32 v72, v216, s76, -v251
    v_fma_f32 v73, v217, s76, -v251
    v_fma_f32 v74, v218, s76, -v251
    v_fma_f32 v75, v219, s76, -v251
    v_fma_f32 v76, v220, s76, -v251
    v_fma_f32 v77, v221, s76, -v251
    v_fma_f32 v78, v222, s76, -v251
    v_fma_f32 v79, v223, s76, -v251
    v_fma_f32 v80, v224, s76, -v251
    v_fma_f32 v81, v225, s76, -v251
    v_fma_f32 v82, v226, s76, -v251
    v_fma_f32 v83, v227, s76, -v251
    v_exp_f32 v68, v68
    v_exp_f32 v69, v69
    v_exp_f32 v70, v70
    v_exp_f32 v71, v71
    v_exp_f32 v72, v72
    v_exp_f32 v73, v73
    v_exp_f32 v74, v74
    v_exp_f32 v75, v75
    v_exp_f32 v76, v76
    v_exp_f32 v77, v77
    v_exp_f32 v78, v78
    v_exp_f32 v79, v79
    v_exp_f32 v80, v80
    v_exp_f32 v81, v81
    v_exp_f32 v82, v82
    v_exp_f32 v83, v83
    v_add_f32 v12, v12, v68
    v_add_f32 v13, v13, v69
    v_cvt_pk_bf16_f32 v52, v68, v69
    v_add_f32 v12, v12, v70
    v_add_f32 v13, v13, v71
    v_cvt_pk_bf16_f32 v53, v70, v71
    v_add_f32 v12, v12, v72
    v_add_f32 v13, v13, v73
    v_cvt_pk_bf16_f32 v54, v72, v73
    v_add_f32 v12, v12, v74
    v_add_f32 v13, v13, v75
    v_cvt_pk_bf16_f32 v55, v74, v75
    v_add_f32 v12, v12, v76
    v_add_f32 v13, v13, v77
    v_cvt_pk_bf16_f32 v56, v76, v77
    v_add_f32 v12, v12, v78
    v_add_f32 v13, v13, v79
    v_cvt_pk_bf16_f32 v57, v78, v79
    v_add_f32 v12, v12, v80
    v_add_f32 v13, v13, v81
    v_cvt_pk_bf16_f32 v58, v80, v81
    v_add_f32 v12, v12, v82
    v_add_f32 v13, v13, v83
    v_cvt_pk_bf16_f32 v59, v82, v83
    ds_write_b128 v248, v[52:55]
    ds_write_b128 v248, v[56:59] offset:1024
    v_add_u32 v248, 8192, v248
    s_add_u32 s70, s70, 4
L_elast:
    s_cmp_eq_u32 s70, s71
    s_cbranch_scc0 L_edone
    v_fma_f32 v68, v228, s76, -v251
    v_fma_f32 v69, v229, s76, -v251
    v_fma_f32 v70, v230, s76, -v251
    v_fma_f32 v71, v231, s76, -v251
    v_fma_f32 v72, v232, s76, -v251
    v_fma_f32 v73, v233, s76, -v251
    v_fma_f32 v74, v234, s76, -v251
    v_fma_f32 v75, v235, s76, -v251
    v_fma_f32 v76, v236, s76, -v251
    v_fma_f32 v77, v237, s76, -v251
    v_fma_f32 v78, v238, s76, -v251
    v_fma_f32 v79, v239, s76, -v251
    v_fma_f32 v80, v240, s76, -v251
    v_fma_f32 v81, v241, s76, -v251
    v_fma_f32 v82, v242, s76, -v251
    v_fma_f32 v83, v243, s76, -v251
    v_exp_f32 v68, v68
    v_exp_f32 v69, v69
    v_exp_f32 v70, v70
    v_exp_f32 v71, v71
    v_exp_f32 v72, v72
    v_exp_f32 v73, v73
    v_exp_f32 v74, v74
    v_exp_f32 v75, v75
    v_exp_f32 v76, v76
    v_exp_f32 v77, v77
    v_exp_f32 v78, v78
    v_exp_f32 v79, v79
    v_exp_f32 v80, v80
    v_exp_f32 v81, v81
    v_exp_f32 v82, v82
    v_exp_f32 v83, v83
    v_add_f32 v12, v12, v68
    v_add_f32 v13, v13, v69
    v_cvt_pk_bf16_f32 v52, v68, v69
    v_add_f32 v12, v12, v70
    v_add_f32 v13, v13, v71
    v_cvt_pk_bf16_f32 v53, v70, v71
    v_add_f32 v12, v12, v72
    v_add_f32 v13, v13, v73
    v_cvt_pk_bf16_f32 v54, v72, v73
    v_add_f32 v12, v12, v74
    v_add_f32 v13, v13, v75
    v_cvt_pk_bf16_f32 v55, v74, v75
    v_add_f32 v12, v12, v76
    v_add_f32 v13, v13, v77
    v_cvt_pk_bf16_f32 v56, v76, v77
    v_add_f32 v12, v12, v78
    v_add_f32 v13, v13, v79
    v_cvt_pk_bf16_f32 v57, v78, v79
    v_add_f32 v12, v12, v80
    v_add_f32 v13, v13, v81
    v_cvt_pk_bf16_f32 v58, v80, v81
    v_add_f32 v12, v12, v82
    v_add_f32 v13, v13, v83
    v_cvt_pk_bf16_f32 v59, v82, v83
    ds_write_b128 v248, v[52:55]
    ds_write_b128 v248, v[56:59] offset:1024
    v_add_u32 v248, 8192, v248
L_edone:
    v_add_f32 v12, v12, v13
    v_mov_b32 v19, v12
    s_nop 1
    v_permlane32_swap_b32 v12, v19
    v_add_f32 v12, v12, v19
    s_add_u32 s75, s75, 1
    v_mov_b32 v249, s75
    s_mov_b32 exec_hi, 0
    ds_write_b32 v16, v12 offset:1856
    s_mov_b64 exec, 1
    ds_write_b32 v15, v249 offset:272
    s_mov_b64 exec, -1
L_sync_48:
    s_sub_u32 s54, s54, 1
    s_cbranch_scc1 L_end
    ds_read_b128 v[60:63], v14 offset:272
    ds_read_b128 v[52:55], v17 offset:1856
    s_waitcnt lgkmcnt(0)
    v_min3_u32 v60, v60, v61, v62
    v_min_u32 v60, v60, v63
    s_nop 0
    v_readfirstlane_b32 s50, v60
    s_cmp_ge_u32 s50, s75
    s_cbranch_scc0 L_sync_48
    v_add_f32 v12, v52, v53
    v_add_f32 v13, v54, v55
    v_add_f32 v12, v12, v13
    s_branch L_pready
L_end:
    s_endpgm
L_code_end:
.section .rodata,"a"
.p2align 6
.amdhsa_kernel standalone__paged_block_table_kv_pagedattention__sampling_kernel
  .amdhsa_next_free_vgpr 254
  .amdhsa_next_free_sgpr 100
  .amdhsa_accum_offset 256
  .amdhsa_group_segment_fixed_size 0
  .amdhsa_kernarg_size 64
  .amdhsa_user_sgpr_count 2
  .amdhsa_user_sgpr_kernarg_segment_ptr 1
  .amdhsa_system_sgpr_workgroup_id_x 1
  .amdhsa_float_denorm_mode_32 3
.end_amdhsa_kernel
```
